```python
import torch

def _softmax(x, axis=-1):
    return torch.softmax(x, dim=axis)
def _gelu(x):
    return torch.nn.functional.gelu(x, approximate="tanh")
def _silu(x):
    return torch.nn.functional.silu(x)
def _sigmoid(x):
    return torch.sigmoid(x)
def _layernorm(x, axis=-1, eps=1e-5):
    m = x.mean(dim=axis, keepdim=True)
    v = x.var(dim=axis, keepdim=True, unbiased=False)
    return (x - m) / torch.sqrt(v + eps)
def _scatter_add(tgt, idx, src, axis=0):
    return tgt.clone().index_add_(axis, idx, src)
def _segment_sum(src, seg, n):
    out = torch.zeros((n,) + src.shape[1:], dtype=src.dtype)
    return out.index_add_(0, seg, src)
def _pad(x, pw):
    flat = tuple(v for pair in reversed(pw) for v in pair)
    return torch.nn.functional.pad(x, flat)

kernel_name = 'parallel_sum__sliding_block__moe_arch_mod__prompt'

def setup_inputs():

    _w = (lambda a: (lambda t: t.to(torch.bfloat16) if t.is_floating_point() else t)(torch.as_tensor(a)))
    def _A_setup():
        B, S, D = 1, 2048, 640
        return {
            "x": _w((lambda *s: torch.randn(*s, dtype=torch.bfloat16) * 0.05)(B, S, D)),
            "wqkv": _w((lambda *s: torch.randn(*s, dtype=torch.bfloat16) * 0.05)(D, 3 * D)),
            "wo": _w((lambda *s: torch.randn(*s, dtype=torch.bfloat16) * 0.05)(D, D)),
        }
    _A_in = _A_setup()

    def _B_setup():
        B, S, D, F, C = 1, 2048, 640, 1536, 2
        return {
            "x": _w((lambda *s: torch.randn(*s, dtype=torch.bfloat16) * 0.05)(B, S, D)),
            "w_r": _w((lambda *s: torch.randn(*s, dtype=torch.bfloat16) * 0.05)(D)),
            "w_gate": _w((lambda *s: torch.randn(*s, dtype=torch.bfloat16) * 0.05)(D, F)),
            "w_up": _w((lambda *s: torch.randn(*s, dtype=torch.bfloat16) * 0.05)(D, F)),
            "w_down": _w((lambda *s: torch.randn(*s, dtype=torch.bfloat16) * 0.05)(F, D)),
        }
    _B_in = _B_setup()

    return {
        "A_x": _A_in["x"],
        "A_wqkv": _A_in["wqkv"],
        "A_wo": _A_in["wo"],
        "B_x": _B_in["x"],
        "B_w_r": _B_in["w_r"],
        "B_w_gate": _B_in["w_gate"],
        "B_w_up": _B_in["w_up"],
        "B_w_down": _B_in["w_down"],
    }

def reference(A_x, A_wqkv, A_wo, B_x, B_w_r, B_w_gate, B_w_up, B_w_down):
    def _A_ref(x, wqkv, wo):
        B, S, D = x.shape
        H = 32; Dh = D // H; W = 256
        qkv = (lambda x, *d: x.permute(*d))((x @ wqkv).reshape(B, S, 3, H, Dh), 2, 0, 3, 1, 4)
        q, k, v = qkv[0], qkv[1], qkv[2]
        scores = torch.einsum("bhqd,bhkd->bhqk", q, k) * (Dh ** -0.5)
        idx = torch.arange(S)
        mask = (idx[:, None] - idx[None, :] >= 0) & (idx[:, None] - idx[None, :] < W)
        scores = torch.where(mask[None, None], scores, -1e9)
        p = _softmax(scores, axis=-1)
        o = torch.einsum("bhqk,bhkd->bhqd", p, v)
        return (lambda x, *d: x.permute(*d))(o, 0, 2, 1, 3).reshape(B, S, D) @ wo

    def _B_ref(x, w_r, w_gate, w_up, w_down):
        B, S, D = x.shape
        C = 2
        r = x @ w_r
        idx = torch.argsort(-r, axis=-1)[:, :C]
        idx_e = (lambda x, n, axis: torch.repeat_interleave(x, n, dim=axis))(idx.reshape(B, C, 1), D, axis=2)
        x_sel = (lambda x, i, axis: torch.take_along_dim(x, i, dim=axis))(x, idx_e, axis=1)
        g = _silu(x_sel @ w_gate)
        u = x_sel @ w_up
        y = (g * u) @ w_down
        r_sel = _sigmoid((lambda x, i, axis: torch.take_along_dim(x, i, dim=axis))(r, idx, axis=1))
        y = y * r_sel.reshape(B, C, 1)
        b_off = (torch.arange(B) * S).reshape(B, 1)
        flat_idx = (idx + b_off).reshape(B * C)
        zero = (x * 0.0).reshape(B * S, D)
        upd = _scatter_add(zero, flat_idx, y.reshape(B * C, D), axis=0)
        return x + upd.reshape(B, S, D)

    x = A_x
    xn = _layernorm(x, axis=-1)
    return x + _A_ref(xn, A_wqkv, A_wo) + _B_ref(xn, B_w_r, B_w_gate, B_w_up, B_w_down)
```

```asm
; @launch grid=(256,1,1) block=(704,1,1) lds=163840
.amdgcn_target "amdgcn-amd-amdhsa--gfx950"
.text
.globl parallel_sum__sliding_block__moe_arch_mod__prompt_kernel
.p2align 8
.type parallel_sum__sliding_block__moe_arch_mod__prompt_kernel,@function
parallel_sum__sliding_block__moe_arch_mod__prompt_kernel:
  s_cmp_ge_u32 s2, 256
  s_cbranch_scc1 L_end
  s_load_dwordx2 s[4:5], s[0:1], 0
  s_load_dwordx2 s[8:9], s[0:1], 8
  s_load_dwordx2 s[12:13], s[0:1], 80
  s_load_dwordx2 s[36:37], s[0:1], 32
  v_and_b32 v1, 63, v0
  v_lshrrev_b32 v2, 6, v0
  s_mov_b32 s100, 0
  s_and_b32 s17, s2, 7
  s_lshr_b32 s18, s2, 3
  v_readfirstlane_b32 s16, v2
  s_and_b32 s46, s17, 1
  s_lshr_b32 s47, s17, 1
  s_lshr_b32 s48, s18, 3
  s_and_b32 s20, s18, 7
  s_lshl_b32 s19, s47, 2
  s_add_u32 s19, s19, s48
  s_mov_b32 s6, 2621440
  s_mov_b32 s7, 0x20000
  s_mov_b32 s10, 2457600
  s_mov_b32 s11, 0x20000
  s_mov_b32 s14, 15728640
  s_mov_b32 s15, 0x20000
  s_mov_b32 s38, 1280
  s_mov_b32 s39, 0x20000
  s_cmp_eq_u32 s16, 10
  s_cbranch_scc1 L_aux
  s_cmp_ge_u32 s16, 8
  s_cbranch_scc1 L_loader
  s_and_b32 s62, s18, 15
  s_lshl_b32 s29, s46, 4
  s_add_u32 s62, s62, s29
  s_lshr_b32 s63, s18, 4
  s_lshl_b32 s29, s47, 1
  s_add_u32 s63, s63, s29
  s_lshl_b32 s34, s63, 8
  s_lshl_b32 s35, s16, 5
  s_add_u32 s34, s34, s35
  v_and_b32 v2, 31, v1
  v_lshrrev_b32 v3, 5, v1
  v_add_u32 v5, s34, v2
  v_lshlrev_b32 v5, 3, v5
  v_lshl_add_u32 v5, v3, 14, v5
  s_mul_i32 s35, s62, 81920
  s_add_u32 s35, s35, 9437184
  v_mov_b32 v6, -1
  v_mov_b32 v7, -1
  s_waitcnt lgkmcnt(0)
  buffer_store_dwordx2 v[6:7], v5, s[12:15], s35 offen sc1
  s_add_u32 s35, s35, 32768
  buffer_store_dwordx2 v[6:7], v5, s[12:15], s35 offen sc1
  s_add_u32 s35, s35, 32768
  s_mov_b32 exec_hi, 0
  buffer_store_dwordx2 v[6:7], v5, s[12:15], s35 offen sc1
  s_mov_b64 exec, -1
  s_cmp_ge_u32 s16, 4
  s_cbranch_scc1 L_ln
  s_and_b32 s21, s16, 1
  s_lshr_b32 s22, s16, 1
  v_and_b32 v2, 31, v1
  v_lshrrev_b32 v3, 5, v1
  s_lshl_b32 s29, s22, 6
  v_add_u32 v4, s29, v2
  v_lshlrev_b32 v4, 7, v4
  v_bfe_u32 v5, v1, 1, 3
  v_xor_b32 v8, v3, v5
  v_xor_b32 v7, 0, v8
  v_lshl_add_u32 v12, v7, 4, v4
  v_xor_b32 v7, 2, v8
  v_lshl_add_u32 v13, v7, 4, v4
  v_xor_b32 v7, 4, v8
  v_lshl_add_u32 v14, v7, 4, v4
  v_xor_b32 v7, 6, v8
  v_lshl_add_u32 v15, v7, 4, v4
  v_bfe_u32 v5, v1, 2, 2
  v_lshl_add_u32 v8, v3, 3, v5
  v_lshlrev_b32 v8, 8, v8
  v_bfe_u32 v9, v1, 4, 1
  v_lshlrev_b32 v9, 5, v9
  v_and_b32 v10, 3, v1
  v_lshlrev_b32 v10, 3, v10
  v_add3_u32 v8, v8, v9, v10
  s_lshl_b32 s29, s21, 1
  s_add_u32 s30, s29, 0
  v_xor_b32 v7, s30, v5
  v_lshl_add_u32 v7, v7, 6, v8
  v_add_u32 v16, 0x10000, v7
  s_add_u32 s30, s29, 1
  v_xor_b32 v7, s30, v5
  v_lshl_add_u32 v7, v7, 6, v8
  v_add_u32 v17, 0x10000, v7
  s_barrier
  ds_read_b128 v[24:27], v12 offset:0
  ds_read_b64_tr_b16 v[32:33], v16 offset:0
  ds_read_b64_tr_b16 v[34:35], v16 offset:1024
  ds_read_b128 v[28:31], v12 offset:4096
  ds_read_b64_tr_b16 v[36:37], v17 offset:0
  ds_read_b64_tr_b16 v[38:39], v17 offset:1024
  ds_read_b128 v[40:43], v13 offset:0
  ds_read_b64_tr_b16 v[48:49], v16 offset:4096
  ds_read_b64_tr_b16 v[50:51], v16 offset:5120
  ds_read_b128 v[44:47], v13 offset:4096
  ds_read_b64_tr_b16 v[52:53], v17 offset:4096
  ds_read_b64_tr_b16 v[54:55], v17 offset:5120
  s_waitcnt lgkmcnt(6)
  v_mfma_f32_32x32x16_bf16 v[72:87], v[32:35], v[24:27], 0
  ds_read_b128 v[56:59], v14 offset:0
  ds_read_b64_tr_b16 v[64:65], v16 offset:8192
  v_mfma_f32_32x32x16_bf16 v[88:103], v[32:35], v[28:31], 0
  ds_read_b64_tr_b16 v[66:67], v16 offset:9216
  ds_read_b128 v[60:63], v14 offset:4096
  v_mfma_f32_32x32x16_bf16 v[104:119], v[36:39], v[24:27], 0
  ds_read_b64_tr_b16 v[68:69], v17 offset:8192
  ds_read_b64_tr_b16 v[70:71], v17 offset:9216
  v_mfma_f32_32x32x16_bf16 v[120:135], v[36:39], v[28:31], 0
  s_waitcnt lgkmcnt(6)
  v_mfma_f32_32x32x16_bf16 v[72:87], v[48:51], v[40:43], v[72:87]
  ds_read_b128 v[24:27], v15 offset:0
  ds_read_b64_tr_b16 v[32:33], v16 offset:12288
  v_mfma_f32_32x32x16_bf16 v[88:103], v[48:51], v[44:47], v[88:103]
  ds_read_b64_tr_b16 v[34:35], v16 offset:13312
  ds_read_b128 v[28:31], v15 offset:4096
  v_mfma_f32_32x32x16_bf16 v[104:119], v[52:55], v[40:43], v[104:119]
  ds_read_b64_tr_b16 v[36:37], v17 offset:12288
  ds_read_b64_tr_b16 v[38:39], v17 offset:13312
  v_mfma_f32_32x32x16_bf16 v[120:135], v[52:55], v[44:47], v[120:135]
  s_barrier
  s_waitcnt lgkmcnt(6)
  v_mfma_f32_32x32x16_bf16 v[72:87], v[64:67], v[56:59], v[72:87]
  ds_read_b128 v[40:43], v12 offset:16384
  ds_read_b64_tr_b16 v[48:49], v16 offset:16384
  v_mfma_f32_32x32x16_bf16 v[88:103], v[64:67], v[60:63], v[88:103]
  ds_read_b64_tr_b16 v[50:51], v16 offset:17408
  ds_read_b128 v[44:47], v12 offset:20480
  v_mfma_f32_32x32x16_bf16 v[104:119], v[68:71], v[56:59], v[104:119]
  ds_read_b64_tr_b16 v[52:53], v17 offset:16384
  ds_read_b64_tr_b16 v[54:55], v17 offset:17408
  v_mfma_f32_32x32x16_bf16 v[120:135], v[68:71], v[60:63], v[120:135]
  s_waitcnt lgkmcnt(6)
  v_mfma_f32_32x32x16_bf16 v[72:87], v[32:35], v[24:27], v[72:87]
  ds_read_b128 v[56:59], v13 offset:16384
  ds_read_b64_tr_b16 v[64:65], v16 offset:20480
  v_mfma_f32_32x32x16_bf16 v[88:103], v[32:35], v[28:31], v[88:103]
  ds_read_b64_tr_b16 v[66:67], v16 offset:21504
  ds_read_b128 v[60:63], v13 offset:20480
  v_mfma_f32_32x32x16_bf16 v[104:119], v[36:39], v[24:27], v[104:119]
  ds_read_b64_tr_b16 v[68:69], v17 offset:20480
  ds_read_b64_tr_b16 v[70:71], v17 offset:21504
  v_mfma_f32_32x32x16_bf16 v[120:135], v[36:39], v[28:31], v[120:135]
  s_waitcnt lgkmcnt(6)
  v_mfma_f32_32x32x16_bf16 v[72:87], v[48:51], v[40:43], v[72:87]
  ds_read_b128 v[24:27], v14 offset:16384
  ds_read_b64_tr_b16 v[32:33], v16 offset:24576
  v_mfma_f32_32x32x16_bf16 v[88:103], v[48:51], v[44:47], v[88:103]
  ds_read_b64_tr_b16 v[34:35], v16 offset:25600
  ds_read_b128 v[28:31], v14 offset:20480
  v_mfma_f32_32x32x16_bf16 v[104:119], v[52:55], v[40:43], v[104:119]
  ds_read_b64_tr_b16 v[36:37], v17 offset:24576
  ds_read_b64_tr_b16 v[38:39], v17 offset:25600
  v_mfma_f32_32x32x16_bf16 v[120:135], v[52:55], v[44:47], v[120:135]
  s_waitcnt lgkmcnt(6)
  v_mfma_f32_32x32x16_bf16 v[72:87], v[64:67], v[56:59], v[72:87]
  ds_read_b128 v[40:43], v15 offset:16384
  ds_read_b64_tr_b16 v[48:49], v16 offset:28672
  v_mfma_f32_32x32x16_bf16 v[88:103], v[64:67], v[60:63], v[88:103]
  ds_read_b64_tr_b16 v[50:51], v16 offset:29696
  ds_read_b128 v[44:47], v15 offset:20480
  v_mfma_f32_32x32x16_bf16 v[104:119], v[68:71], v[56:59], v[104:119]
  ds_read_b64_tr_b16 v[52:53], v17 offset:28672
  ds_read_b64_tr_b16 v[54:55], v17 offset:29696
  v_mfma_f32_32x32x16_bf16 v[120:135], v[68:71], v[60:63], v[120:135]
  s_barrier
  s_waitcnt lgkmcnt(6)
  v_mfma_f32_32x32x16_bf16 v[72:87], v[32:35], v[24:27], v[72:87]
  ds_read_b128 v[56:59], v12 offset:32768
  ds_read_b64_tr_b16 v[64:65], v16 offset:32768
  v_mfma_f32_32x32x16_bf16 v[88:103], v[32:35], v[28:31], v[88:103]
  ds_read_b64_tr_b16 v[66:67], v16 offset:33792
  ds_read_b128 v[60:63], v12 offset:36864
  v_mfma_f32_32x32x16_bf16 v[104:119], v[36:39], v[24:27], v[104:119]
  ds_read_b64_tr_b16 v[68:69], v17 offset:32768
  ds_read_b64_tr_b16 v[70:71], v17 offset:33792
  v_mfma_f32_32x32x16_bf16 v[120:135], v[36:39], v[28:31], v[120:135]
  s_waitcnt lgkmcnt(6)
  v_mfma_f32_32x32x16_bf16 v[72:87], v[48:51], v[40:43], v[72:87]
  ds_read_b128 v[24:27], v13 offset:32768
  ds_read_b64_tr_b16 v[32:33], v16 offset:36864
  v_mfma_f32_32x32x16_bf16 v[88:103], v[48:51], v[44:47], v[88:103]
  ds_read_b64_tr_b16 v[34:35], v16 offset:37888
  ds_read_b128 v[28:31], v13 offset:36864
  v_mfma_f32_32x32x16_bf16 v[104:119], v[52:55], v[40:43], v[104:119]
  ds_read_b64_tr_b16 v[36:37], v17 offset:36864
  ds_read_b64_tr_b16 v[38:39], v17 offset:37888
  v_mfma_f32_32x32x16_bf16 v[120:135], v[52:55], v[44:47], v[120:135]
  s_waitcnt lgkmcnt(6)
  v_mfma_f32_32x32x16_bf16 v[72:87], v[64:67], v[56:59], v[72:87]
  ds_read_b128 v[40:43], v14 offset:32768
  ds_read_b64_tr_b16 v[48:49], v16 offset:40960
  v_mfma_f32_32x32x16_bf16 v[88:103], v[64:67], v[60:63], v[88:103]
  ds_read_b64_tr_b16 v[50:51], v16 offset:41984
  ds_read_b128 v[44:47], v14 offset:36864
  v_mfma_f32_32x32x16_bf16 v[104:119], v[68:71], v[56:59], v[104:119]
  ds_read_b64_tr_b16 v[52:53], v17 offset:40960
  ds_read_b64_tr_b16 v[54:55], v17 offset:41984
  v_mfma_f32_32x32x16_bf16 v[120:135], v[68:71], v[60:63], v[120:135]
  s_waitcnt lgkmcnt(6)
  v_mfma_f32_32x32x16_bf16 v[72:87], v[32:35], v[24:27], v[72:87]
  ds_read_b128 v[56:59], v15 offset:32768
  ds_read_b64_tr_b16 v[64:65], v16 offset:45056
  v_mfma_f32_32x32x16_bf16 v[88:103], v[32:35], v[28:31], v[88:103]
  ds_read_b64_tr_b16 v[66:67], v16 offset:46080
  ds_read_b128 v[60:63], v15 offset:36864
  v_mfma_f32_32x32x16_bf16 v[104:119], v[36:39], v[24:27], v[104:119]
  ds_read_b64_tr_b16 v[68:69], v17 offset:45056
  ds_read_b64_tr_b16 v[70:71], v17 offset:46080
  v_mfma_f32_32x32x16_bf16 v[120:135], v[36:39], v[28:31], v[120:135]
  s_barrier
  s_waitcnt lgkmcnt(6)
  v_mfma_f32_32x32x16_bf16 v[72:87], v[48:51], v[40:43], v[72:87]
  ds_read_b128 v[24:27], v12 offset:49152
  ds_read_b64_tr_b16 v[32:33], v16 offset:49152
  v_mfma_f32_32x32x16_bf16 v[88:103], v[48:51], v[44:47], v[88:103]
  ds_read_b64_tr_b16 v[34:35], v16 offset:50176
  ds_read_b128 v[28:31], v12 offset:53248
  v_mfma_f32_32x32x16_bf16 v[104:119], v[52:55], v[40:43], v[104:119]
  ds_read_b64_tr_b16 v[36:37], v17 offset:49152
  ds_read_b64_tr_b16 v[38:39], v17 offset:50176
  v_mfma_f32_32x32x16_bf16 v[120:135], v[52:55], v[44:47], v[120:135]
  s_waitcnt lgkmcnt(6)
  v_mfma_f32_32x32x16_bf16 v[72:87], v[64:67], v[56:59], v[72:87]
  ds_read_b128 v[40:43], v13 offset:49152
  ds_read_b64_tr_b16 v[48:49], v16 offset:53248
  v_mfma_f32_32x32x16_bf16 v[88:103], v[64:67], v[60:63], v[88:103]
  ds_read_b64_tr_b16 v[50:51], v16 offset:54272
  ds_read_b128 v[44:47], v13 offset:53248
  v_mfma_f32_32x32x16_bf16 v[104:119], v[68:71], v[56:59], v[104:119]
  ds_read_b64_tr_b16 v[52:53], v17 offset:53248
  ds_read_b64_tr_b16 v[54:55], v17 offset:54272
  v_mfma_f32_32x32x16_bf16 v[120:135], v[68:71], v[60:63], v[120:135]
  s_waitcnt lgkmcnt(6)
  v_mfma_f32_32x32x16_bf16 v[72:87], v[32:35], v[24:27], v[72:87]
  ds_read_b128 v[56:59], v14 offset:49152
  ds_read_b64_tr_b16 v[64:65], v16 offset:57344
  v_mfma_f32_32x32x16_bf16 v[88:103], v[32:35], v[28:31], v[88:103]
  ds_read_b64_tr_b16 v[66:67], v16 offset:58368
  ds_read_b128 v[60:63], v14 offset:53248
  v_mfma_f32_32x32x16_bf16 v[104:119], v[36:39], v[24:27], v[104:119]
  ds_read_b64_tr_b16 v[68:69], v17 offset:57344
  ds_read_b64_tr_b16 v[70:71], v17 offset:58368
  v_mfma_f32_32x32x16_bf16 v[120:135], v[36:39], v[28:31], v[120:135]
  s_waitcnt lgkmcnt(6)
  v_mfma_f32_32x32x16_bf16 v[72:87], v[48:51], v[40:43], v[72:87]
  ds_read_b128 v[24:27], v15 offset:49152
  ds_read_b64_tr_b16 v[32:33], v16 offset:61440
  v_mfma_f32_32x32x16_bf16 v[88:103], v[48:51], v[44:47], v[88:103]
  ds_read_b64_tr_b16 v[34:35], v16 offset:62464
  ds_read_b128 v[28:31], v15 offset:53248
  v_mfma_f32_32x32x16_bf16 v[104:119], v[52:55], v[40:43], v[104:119]
  ds_read_b64_tr_b16 v[36:37], v17 offset:61440
  ds_read_b64_tr_b16 v[38:39], v17 offset:62464
  v_mfma_f32_32x32x16_bf16 v[120:135], v[52:55], v[44:47], v[120:135]
  s_barrier
  s_waitcnt lgkmcnt(6)
  v_mfma_f32_32x32x16_bf16 v[72:87], v[64:67], v[56:59], v[72:87]
  ds_read_b128 v[40:43], v12 offset:0
  ds_read_b64_tr_b16 v[48:49], v16 offset:0
  v_mfma_f32_32x32x16_bf16 v[88:103], v[64:67], v[60:63], v[88:103]
  ds_read_b64_tr_b16 v[50:51], v16 offset:1024
  ds_read_b128 v[44:47], v12 offset:4096
  v_mfma_f32_32x32x16_bf16 v[104:119], v[68:71], v[56:59], v[104:119]
  ds_read_b64_tr_b16 v[52:53], v17 offset:0
  ds_read_b64_tr_b16 v[54:55], v17 offset:1024
  v_mfma_f32_32x32x16_bf16 v[120:135], v[68:71], v[60:63], v[120:135]
  s_waitcnt lgkmcnt(6)
  v_mfma_f32_32x32x16_bf16 v[72:87], v[32:35], v[24:27], v[72:87]
  ds_read_b128 v[56:59], v13 offset:0
  ds_read_b64_tr_b16 v[64:65], v16 offset:4096
  v_mfma_f32_32x32x16_bf16 v[88:103], v[32:35], v[28:31], v[88:103]
  ds_read_b64_tr_b16 v[66:67], v16 offset:5120
  ds_read_b128 v[60:63], v13 offset:4096
  v_mfma_f32_32x32x16_bf16 v[104:119], v[36:39], v[24:27], v[104:119]
  ds_read_b64_tr_b16 v[68:69], v17 offset:4096
  ds_read_b64_tr_b16 v[70:71], v17 offset:5120
  v_mfma_f32_32x32x16_bf16 v[120:135], v[36:39], v[28:31], v[120:135]
  s_waitcnt lgkmcnt(6)
  v_mfma_f32_32x32x16_bf16 v[72:87], v[48:51], v[40:43], v[72:87]
  ds_read_b128 v[24:27], v14 offset:0
  ds_read_b64_tr_b16 v[32:33], v16 offset:8192
  v_mfma_f32_32x32x16_bf16 v[88:103], v[48:51], v[44:47], v[88:103]
  ds_read_b64_tr_b16 v[34:35], v16 offset:9216
  ds_read_b128 v[28:31], v14 offset:4096
  v_mfma_f32_32x32x16_bf16 v[104:119], v[52:55], v[40:43], v[104:119]
  ds_read_b64_tr_b16 v[36:37], v17 offset:8192
  ds_read_b64_tr_b16 v[38:39], v17 offset:9216
  v_mfma_f32_32x32x16_bf16 v[120:135], v[52:55], v[44:47], v[120:135]
  s_waitcnt lgkmcnt(6)
  v_mfma_f32_32x32x16_bf16 v[72:87], v[64:67], v[56:59], v[72:87]
  ds_read_b128 v[40:43], v15 offset:0
  ds_read_b64_tr_b16 v[48:49], v16 offset:12288
  v_mfma_f32_32x32x16_bf16 v[88:103], v[64:67], v[60:63], v[88:103]
  ds_read_b64_tr_b16 v[50:51], v16 offset:13312
  ds_read_b128 v[44:47], v15 offset:4096
  v_mfma_f32_32x32x16_bf16 v[104:119], v[68:71], v[56:59], v[104:119]
  ds_read_b64_tr_b16 v[52:53], v17 offset:12288
  ds_read_b64_tr_b16 v[54:55], v17 offset:13312
  v_mfma_f32_32x32x16_bf16 v[120:135], v[68:71], v[60:63], v[120:135]
  s_barrier
  s_waitcnt lgkmcnt(6)
  v_mfma_f32_32x32x16_bf16 v[72:87], v[32:35], v[24:27], v[72:87]
  ds_read_b128 v[56:59], v12 offset:16384
  ds_read_b64_tr_b16 v[64:65], v16 offset:16384
  v_mfma_f32_32x32x16_bf16 v[88:103], v[32:35], v[28:31], v[88:103]
  ds_read_b64_tr_b16 v[66:67], v16 offset:17408
  ds_read_b128 v[60:63], v12 offset:20480
  v_mfma_f32_32x32x16_bf16 v[104:119], v[36:39], v[24:27], v[104:119]
  ds_read_b64_tr_b16 v[68:69], v17 offset:16384
  ds_read_b64_tr_b16 v[70:71], v17 offset:17408
  v_mfma_f32_32x32x16_bf16 v[120:135], v[36:39], v[28:31], v[120:135]
  s_waitcnt lgkmcnt(6)
  v_mfma_f32_32x32x16_bf16 v[72:87], v[48:51], v[40:43], v[72:87]
  ds_read_b128 v[24:27], v13 offset:16384
  ds_read_b64_tr_b16 v[32:33], v16 offset:20480
  v_mfma_f32_32x32x16_bf16 v[88:103], v[48:51], v[44:47], v[88:103]
  ds_read_b64_tr_b16 v[34:35], v16 offset:21504
  ds_read_b128 v[28:31], v13 offset:20480
  v_mfma_f32_32x32x16_bf16 v[104:119], v[52:55], v[40:43], v[104:119]
  ds_read_b64_tr_b16 v[36:37], v17 offset:20480
  ds_read_b64_tr_b16 v[38:39], v17 offset:21504
  v_mfma_f32_32x32x16_bf16 v[120:135], v[52:55], v[44:47], v[120:135]
  s_waitcnt lgkmcnt(6)
  v_mfma_f32_32x32x16_bf16 v[72:87], v[64:67], v[56:59], v[72:87]
  ds_read_b128 v[40:43], v14 offset:16384
  ds_read_b64_tr_b16 v[48:49], v16 offset:24576
  v_mfma_f32_32x32x16_bf16 v[88:103], v[64:67], v[60:63], v[88:103]
  ds_read_b64_tr_b16 v[50:51], v16 offset:25600
  ds_read_b128 v[44:47], v14 offset:20480
  v_mfma_f32_32x32x16_bf16 v[104:119], v[68:71], v[56:59], v[104:119]
  ds_read_b64_tr_b16 v[52:53], v17 offset:24576
  ds_read_b64_tr_b16 v[54:55], v17 offset:25600
  v_mfma_f32_32x32x16_bf16 v[120:135], v[68:71], v[60:63], v[120:135]
  s_waitcnt lgkmcnt(6)
  v_mfma_f32_32x32x16_bf16 v[72:87], v[32:35], v[24:27], v[72:87]
  ds_read_b128 v[56:59], v15 offset:16384
  ds_read_b64_tr_b16 v[64:65], v16 offset:28672
  v_mfma_f32_32x32x16_bf16 v[88:103], v[32:35], v[28:31], v[88:103]
  ds_read_b64_tr_b16 v[66:67], v16 offset:29696
  ds_read_b128 v[60:63], v15 offset:20480
  v_mfma_f32_32x32x16_bf16 v[104:119], v[36:39], v[24:27], v[104:119]
  ds_read_b64_tr_b16 v[68:69], v17 offset:28672
  ds_read_b64_tr_b16 v[70:71], v17 offset:29696
  v_mfma_f32_32x32x16_bf16 v[120:135], v[36:39], v[28:31], v[120:135]
  s_barrier
  s_waitcnt lgkmcnt(6)
  v_mfma_f32_32x32x16_bf16 v[72:87], v[48:51], v[40:43], v[72:87]
  ds_read_b128 v[24:27], v12 offset:32768
  ds_read_b64_tr_b16 v[32:33], v16 offset:32768
  v_mfma_f32_32x32x16_bf16 v[88:103], v[48:51], v[44:47], v[88:103]
  ds_read_b64_tr_b16 v[34:35], v16 offset:33792
  ds_read_b128 v[28:31], v12 offset:36864
  v_mfma_f32_32x32x16_bf16 v[104:119], v[52:55], v[40:43], v[104:119]
  ds_read_b64_tr_b16 v[36:37], v17 offset:32768
  ds_read_b64_tr_b16 v[38:39], v17 offset:33792
  v_mfma_f32_32x32x16_bf16 v[120:135], v[52:55], v[44:47], v[120:135]
  s_waitcnt lgkmcnt(6)
  v_mfma_f32_32x32x16_bf16 v[72:87], v[64:67], v[56:59], v[72:87]
  ds_read_b128 v[40:43], v13 offset:32768
  ds_read_b64_tr_b16 v[48:49], v16 offset:36864
  v_mfma_f32_32x32x16_bf16 v[88:103], v[64:67], v[60:63], v[88:103]
  ds_read_b64_tr_b16 v[50:51], v16 offset:37888
  ds_read_b128 v[44:47], v13 offset:36864
  v_mfma_f32_32x32x16_bf16 v[104:119], v[68:71], v[56:59], v[104:119]
  ds_read_b64_tr_b16 v[52:53], v17 offset:36864
  ds_read_b64_tr_b16 v[54:55], v17 offset:37888
  v_mfma_f32_32x32x16_bf16 v[120:135], v[68:71], v[60:63], v[120:135]
  s_waitcnt lgkmcnt(6)
  v_mfma_f32_32x32x16_bf16 v[72:87], v[32:35], v[24:27], v[72:87]
  ds_read_b128 v[56:59], v14 offset:32768
  ds_read_b64_tr_b16 v[64:65], v16 offset:40960
  v_mfma_f32_32x32x16_bf16 v[88:103], v[32:35], v[28:31], v[88:103]
  ds_read_b64_tr_b16 v[66:67], v16 offset:41984
  ds_read_b128 v[60:63], v14 offset:36864
  v_mfma_f32_32x32x16_bf16 v[104:119], v[36:39], v[24:27], v[104:119]
  ds_read_b64_tr_b16 v[68:69], v17 offset:40960
  ds_read_b64_tr_b16 v[70:71], v17 offset:41984
  v_mfma_f32_32x32x16_bf16 v[120:135], v[36:39], v[28:31], v[120:135]
  s_waitcnt lgkmcnt(6)
  v_mfma_f32_32x32x16_bf16 v[72:87], v[48:51], v[40:43], v[72:87]
  ds_read_b128 v[24:27], v15 offset:32768
  ds_read_b64_tr_b16 v[32:33], v16 offset:45056
  v_mfma_f32_32x32x16_bf16 v[88:103], v[48:51], v[44:47], v[88:103]
  ds_read_b64_tr_b16 v[34:35], v16 offset:46080
  ds_read_b128 v[28:31], v15 offset:36864
  v_mfma_f32_32x32x16_bf16 v[104:119], v[52:55], v[40:43], v[104:119]
  ds_read_b64_tr_b16 v[36:37], v17 offset:45056
  ds_read_b64_tr_b16 v[38:39], v17 offset:46080
  v_mfma_f32_32x32x16_bf16 v[120:135], v[52:55], v[44:47], v[120:135]
  s_barrier
  s_waitcnt lgkmcnt(6)
  v_mfma_f32_32x32x16_bf16 v[72:87], v[64:67], v[56:59], v[72:87]
  ds_read_b128 v[40:43], v12 offset:49152
  ds_read_b64_tr_b16 v[48:49], v16 offset:49152
  v_mfma_f32_32x32x16_bf16 v[88:103], v[64:67], v[60:63], v[88:103]
  ds_read_b64_tr_b16 v[50:51], v16 offset:50176
  ds_read_b128 v[44:47], v12 offset:53248
  v_mfma_f32_32x32x16_bf16 v[104:119], v[68:71], v[56:59], v[104:119]
  ds_read_b64_tr_b16 v[52:53], v17 offset:49152
  ds_read_b64_tr_b16 v[54:55], v17 offset:50176
  v_mfma_f32_32x32x16_bf16 v[120:135], v[68:71], v[60:63], v[120:135]
  s_waitcnt lgkmcnt(6)
  v_mfma_f32_32x32x16_bf16 v[72:87], v[32:35], v[24:27], v[72:87]
  ds_read_b128 v[56:59], v13 offset:49152
  ds_read_b64_tr_b16 v[64:65], v16 offset:53248
  v_mfma_f32_32x32x16_bf16 v[88:103], v[32:35], v[28:31], v[88:103]
  ds_read_b64_tr_b16 v[66:67], v16 offset:54272
  ds_read_b128 v[60:63], v13 offset:53248
  v_mfma_f32_32x32x16_bf16 v[104:119], v[36:39], v[24:27], v[104:119]
  ds_read_b64_tr_b16 v[68:69], v17 offset:53248
  ds_read_b64_tr_b16 v[70:71], v17 offset:54272
  v_mfma_f32_32x32x16_bf16 v[120:135], v[36:39], v[28:31], v[120:135]
  s_waitcnt lgkmcnt(6)
  v_mfma_f32_32x32x16_bf16 v[72:87], v[48:51], v[40:43], v[72:87]
  ds_read_b128 v[24:27], v14 offset:49152
  ds_read_b64_tr_b16 v[32:33], v16 offset:57344
  v_mfma_f32_32x32x16_bf16 v[88:103], v[48:51], v[44:47], v[88:103]
  ds_read_b64_tr_b16 v[34:35], v16 offset:58368
  ds_read_b128 v[28:31], v14 offset:53248
  v_mfma_f32_32x32x16_bf16 v[104:119], v[52:55], v[40:43], v[104:119]
  ds_read_b64_tr_b16 v[36:37], v17 offset:57344
  ds_read_b64_tr_b16 v[38:39], v17 offset:58368
  v_mfma_f32_32x32x16_bf16 v[120:135], v[52:55], v[44:47], v[120:135]
  s_waitcnt lgkmcnt(6)
  v_mfma_f32_32x32x16_bf16 v[72:87], v[64:67], v[56:59], v[72:87]
  ds_read_b128 v[40:43], v15 offset:49152
  ds_read_b64_tr_b16 v[48:49], v16 offset:61440
  v_mfma_f32_32x32x16_bf16 v[88:103], v[64:67], v[60:63], v[88:103]
  ds_read_b64_tr_b16 v[50:51], v16 offset:62464
  ds_read_b128 v[44:47], v15 offset:53248
  v_mfma_f32_32x32x16_bf16 v[104:119], v[68:71], v[56:59], v[104:119]
  ds_read_b64_tr_b16 v[52:53], v17 offset:61440
  ds_read_b64_tr_b16 v[54:55], v17 offset:62464
  v_mfma_f32_32x32x16_bf16 v[120:135], v[68:71], v[60:63], v[120:135]
  s_barrier
  s_waitcnt lgkmcnt(6)
  v_mfma_f32_32x32x16_bf16 v[72:87], v[32:35], v[24:27], v[72:87]
  ds_read_b128 v[56:59], v12 offset:0
  ds_read_b64_tr_b16 v[64:65], v16 offset:0
  v_mfma_f32_32x32x16_bf16 v[88:103], v[32:35], v[28:31], v[88:103]
  ds_read_b64_tr_b16 v[66:67], v16 offset:1024
  ds_read_b128 v[60:63], v12 offset:4096
  v_mfma_f32_32x32x16_bf16 v[104:119], v[36:39], v[24:27], v[104:119]
  ds_read_b64_tr_b16 v[68:69], v17 offset:0
  ds_read_b64_tr_b16 v[70:71], v17 offset:1024
  v_mfma_f32_32x32x16_bf16 v[120:135], v[36:39], v[28:31], v[120:135]
  s_waitcnt lgkmcnt(6)
  v_mfma_f32_32x32x16_bf16 v[72:87], v[48:51], v[40:43], v[72:87]
  ds_read_b128 v[24:27], v13 offset:0
  ds_read_b64_tr_b16 v[32:33], v16 offset:4096
  v_mfma_f32_32x32x16_bf16 v[88:103], v[48:51], v[44:47], v[88:103]
  ds_read_b64_tr_b16 v[34:35], v16 offset:5120
  ds_read_b128 v[28:31], v13 offset:4096
  v_mfma_f32_32x32x16_bf16 v[104:119], v[52:55], v[40:43], v[104:119]
  ds_read_b64_tr_b16 v[36:37], v17 offset:4096
  ds_read_b64_tr_b16 v[38:39], v17 offset:5120
  v_mfma_f32_32x32x16_bf16 v[120:135], v[52:55], v[44:47], v[120:135]
  s_waitcnt lgkmcnt(6)
  v_mfma_f32_32x32x16_bf16 v[72:87], v[64:67], v[56:59], v[72:87]
  ds_read_b128 v[40:43], v14 offset:0
  ds_read_b64_tr_b16 v[48:49], v16 offset:8192
  v_mfma_f32_32x32x16_bf16 v[88:103], v[64:67], v[60:63], v[88:103]
  ds_read_b64_tr_b16 v[50:51], v16 offset:9216
  ds_read_b128 v[44:47], v14 offset:4096
  v_mfma_f32_32x32x16_bf16 v[104:119], v[68:71], v[56:59], v[104:119]
  ds_read_b64_tr_b16 v[52:53], v17 offset:8192
  ds_read_b64_tr_b16 v[54:55], v17 offset:9216
  v_mfma_f32_32x32x16_bf16 v[120:135], v[68:71], v[60:63], v[120:135]
  s_waitcnt lgkmcnt(6)
  v_mfma_f32_32x32x16_bf16 v[72:87], v[32:35], v[24:27], v[72:87]
  ds_read_b128 v[56:59], v15 offset:0
  ds_read_b64_tr_b16 v[64:65], v16 offset:12288
  v_mfma_f32_32x32x16_bf16 v[88:103], v[32:35], v[28:31], v[88:103]
  ds_read_b64_tr_b16 v[66:67], v16 offset:13312
  ds_read_b128 v[60:63], v15 offset:4096
  v_mfma_f32_32x32x16_bf16 v[104:119], v[36:39], v[24:27], v[104:119]
  ds_read_b64_tr_b16 v[68:69], v17 offset:12288
  ds_read_b64_tr_b16 v[70:71], v17 offset:13312
  v_mfma_f32_32x32x16_bf16 v[120:135], v[36:39], v[28:31], v[120:135]
  s_barrier
  s_waitcnt lgkmcnt(6)
  v_mfma_f32_32x32x16_bf16 v[72:87], v[48:51], v[40:43], v[72:87]
  ds_read_b128 v[24:27], v12 offset:16384
  ds_read_b64_tr_b16 v[32:33], v16 offset:16384
  v_mfma_f32_32x32x16_bf16 v[88:103], v[48:51], v[44:47], v[88:103]
  ds_read_b64_tr_b16 v[34:35], v16 offset:17408
  ds_read_b128 v[28:31], v12 offset:20480
  v_mfma_f32_32x32x16_bf16 v[104:119], v[52:55], v[40:43], v[104:119]
  ds_read_b64_tr_b16 v[36:37], v17 offset:16384
  ds_read_b64_tr_b16 v[38:39], v17 offset:17408
  v_mfma_f32_32x32x16_bf16 v[120:135], v[52:55], v[44:47], v[120:135]
  s_waitcnt lgkmcnt(6)
  v_mfma_f32_32x32x16_bf16 v[72:87], v[64:67], v[56:59], v[72:87]
  ds_read_b128 v[40:43], v13 offset:16384
  ds_read_b64_tr_b16 v[48:49], v16 offset:20480
  v_mfma_f32_32x32x16_bf16 v[88:103], v[64:67], v[60:63], v[88:103]
  ds_read_b64_tr_b16 v[50:51], v16 offset:21504
  ds_read_b128 v[44:47], v13 offset:20480
  v_mfma_f32_32x32x16_bf16 v[104:119], v[68:71], v[56:59], v[104:119]
  ds_read_b64_tr_b16 v[52:53], v17 offset:20480
  ds_read_b64_tr_b16 v[54:55], v17 offset:21504
  v_mfma_f32_32x32x16_bf16 v[120:135], v[68:71], v[60:63], v[120:135]
  s_waitcnt lgkmcnt(6)
  v_mfma_f32_32x32x16_bf16 v[72:87], v[32:35], v[24:27], v[72:87]
  ds_read_b128 v[56:59], v14 offset:16384
  ds_read_b64_tr_b16 v[64:65], v16 offset:24576
  v_mfma_f32_32x32x16_bf16 v[88:103], v[32:35], v[28:31], v[88:103]
  ds_read_b64_tr_b16 v[66:67], v16 offset:25600
  ds_read_b128 v[60:63], v14 offset:20480
  v_mfma_f32_32x32x16_bf16 v[104:119], v[36:39], v[24:27], v[104:119]
  ds_read_b64_tr_b16 v[68:69], v17 offset:24576
  ds_read_b64_tr_b16 v[70:71], v17 offset:25600
  v_mfma_f32_32x32x16_bf16 v[120:135], v[36:39], v[28:31], v[120:135]
  s_waitcnt lgkmcnt(6)
  v_mfma_f32_32x32x16_bf16 v[72:87], v[48:51], v[40:43], v[72:87]
  ds_read_b128 v[24:27], v15 offset:16384
  ds_read_b64_tr_b16 v[32:33], v16 offset:28672
  v_mfma_f32_32x32x16_bf16 v[88:103], v[48:51], v[44:47], v[88:103]
  ds_read_b64_tr_b16 v[34:35], v16 offset:29696
  ds_read_b128 v[28:31], v15 offset:20480
  v_mfma_f32_32x32x16_bf16 v[104:119], v[52:55], v[40:43], v[104:119]
  ds_read_b64_tr_b16 v[36:37], v17 offset:28672
  ds_read_b64_tr_b16 v[38:39], v17 offset:29696
  v_mfma_f32_32x32x16_bf16 v[120:135], v[52:55], v[44:47], v[120:135]
  s_waitcnt lgkmcnt(6)
  v_mfma_f32_32x32x16_bf16 v[72:87], v[64:67], v[56:59], v[72:87]
  v_mfma_f32_32x32x16_bf16 v[88:103], v[64:67], v[60:63], v[88:103]
  v_mfma_f32_32x32x16_bf16 v[104:119], v[68:71], v[56:59], v[104:119]
  v_mfma_f32_32x32x16_bf16 v[120:135], v[68:71], v[60:63], v[120:135]
  s_waitcnt lgkmcnt(0)
  v_mfma_f32_32x32x16_bf16 v[72:87], v[32:35], v[24:27], v[72:87]
  v_mfma_f32_32x32x16_bf16 v[88:103], v[32:35], v[28:31], v[88:103]
  v_mfma_f32_32x32x16_bf16 v[104:119], v[36:39], v[24:27], v[104:119]
  v_mfma_f32_32x32x16_bf16 v[120:135], v[36:39], v[28:31], v[120:135]
L_a_bE1:
  s_barrier
  s_cmp_ge_u32 s16, 4
  s_cbranch_scc1 L_a_e2
  s_lshl_b32 s29, s22, 9
  s_add_u32 s29, s29, 131072
  v_lshl_add_u32 v4, v2, 3, s29
  ds_read_b64 v[20:21], v4
  ds_read_b64 v[22:23], v4 offset:256
  s_lshl_b32 s29, s21, 8
  s_add_u32 s29, s29, 133248
  v_lshl_add_u32 v4, v2, 2, s29
  ds_read_b32 v44, v4 offset:0
  ds_read_b32 v45, v4 offset:128
  ds_read_b32 v46, v4 offset:512
  ds_read_b32 v47, v4 offset:640
  ds_read_b32 v48, v4 offset:1024
  ds_read_b32 v49, v4 offset:1152
  ds_read_b32 v50, v4 offset:1536
  ds_read_b32 v51, v4 offset:1664
  v_mov_b32 v5, 137472
  ds_read_b32 v6, v5
  s_lshl_b32 s33, s19, 7
  s_lshl_b32 s34, s22, 6
  s_add_u32 s33, s33, s34
  v_add_u32 v4, s33, v2
  v_lshlrev_b32 v4, 4, v4
  v_lshl_add_u32 v4, v3, 15, v4
  v_mov_b32 v29, 0
  v_mov_b32 v30, 0
  v_mov_b32 v31, 0
  v_mov_b32 v33, 0
  v_mov_b32 v34, 0
  v_mov_b32 v35, 0
  v_mov_b32 v37, 0
  v_mov_b32 v38, 0
  v_mov_b32 v39, 0
  v_mov_b32 v41, 0
  v_mov_b32 v42, 0
  v_mov_b32 v43, 0
  v_cmp_gt_u32 vcc, 32, v1
  v_mov_b32 v7, 0
  s_waitcnt lgkmcnt(0)
  v_readfirstlane_b32 s41, v6
  v_add_f32 v24, v44, v46
  v_add_f32 v25, v45, v47
  v_add_f32 v48, v48, v50
  v_add_f32 v49, v49, v51
  v_add_f32 v24, v24, v48
  v_add_f32 v25, v25, v49
  v_cvt_pk_bf16_f32 v8, v24, v24
  v_lshlrev_b32 v8, 16, v8
  v_sub_f32 v8, v24, v8
  v_cvt_pk_bf16_f32 v8, v24, v8
  v_cndmask_b32 v28, v7, v8, vcc
  v_cvt_pk_bf16_f32 v8, v25, v25
  v_lshlrev_b32 v8, 16, v8
  v_sub_f32 v8, v25, v8
  v_cvt_pk_bf16_f32 v8, v25, v8
  v_cndmask_b32 v32, v7, v8, vcc
  v_sub_f32 v8, 0, v20
  v_cvt_pk_bf16_f32 v8, v8, v8
  v_cndmask_b32 v36, v7, v8, vcc
  v_sub_f32 v8, 0, v22
  v_cvt_pk_bf16_f32 v8, v8, v8
  v_cndmask_b32 v40, v7, v8, vcc
  v_mfma_f32_32x32x16_bf16 v[72:87], v[28:31], v[36:39], v[72:87]
  s_nop 0
  v_mfma_f32_32x32x16_bf16 v[88:103], v[28:31], v[40:43], v[88:103]
  v_mfma_f32_32x32x16_bf16 v[104:119], v[32:35], v[36:39], v[104:119]
  v_mfma_f32_32x32x16_bf16 v[120:135], v[32:35], v[40:43], v[120:135]
  s_lshl_b32 s29, s20, 2
  s_lshl_b32 s30, s21, 1
  s_add_u32 s29, s29, s30
  s_add_u32 s29, s29, 0
  s_cmp_ge_u32 s29, 30
  s_cbranch_scc1 L_askip_1
  s_mul_i32 s32, s29, 26
  s_lshr_b32 s32, s32, 8
  s_add_u32 s32, s32, s46
  s_mul_i32 s32, s32, 40
  s_lshl_b32 s31, s29, 2
  s_add_u32 s31, s31, s32
  s_lshl_b32 s31, s31, 15
  s_add_u32 s31, s31, 1048576
  s_cmp_lt_u32 s29, 10
  s_cselect_b32 s40, 0x3ea52b5c, 1.0
  v_mul_f32 v56, s40, v21
  v_mul_f32 v58, s40, v23
  v_mov_b32 v57, v56
  v_mov_b32 v59, v58
  v_pk_mul_f32 v[72:73], v[72:73], v[56:57]
  v_pk_mul_f32 v[74:75], v[74:75], v[56:57]
  v_pk_mul_f32 v[76:77], v[76:77], v[56:57]
  v_pk_mul_f32 v[78:79], v[78:79], v[56:57]
  v_pk_mul_f32 v[80:81], v[80:81], v[56:57]
  v_pk_mul_f32 v[82:83], v[82:83], v[56:57]
  v_pk_mul_f32 v[84:85], v[84:85], v[56:57]
  v_pk_mul_f32 v[86:87], v[86:87], v[56:57]
  v_cvt_pk_bf16_f32 v136, v72, v73
  v_cvt_pk_bf16_f32 v137, v74, v75
  v_cvt_pk_bf16_f32 v138, v76, v77
  v_cvt_pk_bf16_f32 v139, v78, v79
  v_cvt_pk_bf16_f32 v140, v80, v81
  v_cvt_pk_bf16_f32 v141, v82, v83
  v_cvt_pk_bf16_f32 v142, v84, v85
  v_cvt_pk_bf16_f32 v143, v86, v87
  v_permlane32_swap_b32 v136, v138
  v_permlane32_swap_b32 v137, v139
  v_permlane32_swap_b32 v140, v142
  v_permlane32_swap_b32 v141, v143
  v_pk_mul_f32 v[88:89], v[88:89], v[58:59]
  v_pk_mul_f32 v[90:91], v[90:91], v[58:59]
  v_pk_mul_f32 v[92:93], v[92:93], v[58:59]
  v_pk_mul_f32 v[94:95], v[94:95], v[58:59]
  v_pk_mul_f32 v[96:97], v[96:97], v[58:59]
  v_pk_mul_f32 v[98:99], v[98:99], v[58:59]
  v_pk_mul_f32 v[100:101], v[100:101], v[58:59]
  v_pk_mul_f32 v[102:103], v[102:103], v[58:59]
  v_cvt_pk_bf16_f32 v144, v88, v89
  v_cvt_pk_bf16_f32 v145, v90, v91
  v_cvt_pk_bf16_f32 v146, v92, v93
  v_cvt_pk_bf16_f32 v147, v94, v95
  v_cvt_pk_bf16_f32 v148, v96, v97
  v_cvt_pk_bf16_f32 v149, v98, v99
  v_cvt_pk_bf16_f32 v150, v100, v101
  v_cvt_pk_bf16_f32 v151, v102, v103
  v_permlane32_swap_b32 v144, v146
  v_permlane32_swap_b32 v145, v147
  v_permlane32_swap_b32 v148, v150
  v_permlane32_swap_b32 v149, v151
  s_cmp_eq_u32 s41, 1
  s_cbranch_scc1 L_afast_2
  s_add_u32 s32, s31, 0
  buffer_store_dwordx4 v[136:139], v4, s[12:15], s32 offen offset:0 sc1
  buffer_store_dwordx4 v[144:147], v4, s[12:15], s32 offen offset:512 sc1
  s_add_u32 s32, s31, 65536
  buffer_store_dwordx4 v[140:143], v4, s[12:15], s32 offen offset:0 sc1
  buffer_store_dwordx4 v[148:151], v4, s[12:15], s32 offen offset:512 sc1
  s_branch L_adone_3
L_afast_2:
  s_add_u32 s32, s31, 0
  buffer_store_dwordx4 v[136:139], v4, s[12:15], s32 offen offset:0
  buffer_store_dwordx4 v[144:147], v4, s[12:15], s32 offen offset:512
  s_add_u32 s32, s31, 65536
  buffer_store_dwordx4 v[140:143], v4, s[12:15], s32 offen offset:0
  buffer_store_dwordx4 v[148:151], v4, s[12:15], s32 offen offset:512
L_adone_3:
L_askip_1:
  s_lshl_b32 s29, s20, 2
  s_lshl_b32 s30, s21, 1
  s_add_u32 s29, s29, s30
  s_add_u32 s29, s29, 1
  s_cmp_ge_u32 s29, 30
  s_cbranch_scc1 L_askip_4
  s_mul_i32 s32, s29, 26
  s_lshr_b32 s32, s32, 8
  s_add_u32 s32, s32, s46
  s_mul_i32 s32, s32, 40
  s_lshl_b32 s31, s29, 2
  s_add_u32 s31, s31, s32
  s_lshl_b32 s31, s31, 15
  s_add_u32 s31, s31, 1048576
  s_cmp_lt_u32 s29, 10
  s_cselect_b32 s40, 0x3ea52b5c, 1.0
  v_mul_f32 v56, s40, v21
  v_mul_f32 v58, s40, v23
  v_mov_b32 v57, v56
  v_mov_b32 v59, v58
  v_pk_mul_f32 v[104:105], v[104:105], v[56:57]
  v_pk_mul_f32 v[106:107], v[106:107], v[56:57]
  v_pk_mul_f32 v[108:109], v[108:109], v[56:57]
  v_pk_mul_f32 v[110:111], v[110:111], v[56:57]
  v_pk_mul_f32 v[112:113], v[112:113], v[56:57]
  v_pk_mul_f32 v[114:115], v[114:115], v[56:57]
  v_pk_mul_f32 v[116:117], v[116:117], v[56:57]
  v_pk_mul_f32 v[118:119], v[118:119], v[56:57]
  v_cvt_pk_bf16_f32 v152, v104, v105
  v_cvt_pk_bf16_f32 v153, v106, v107
  v_cvt_pk_bf16_f32 v154, v108, v109
  v_cvt_pk_bf16_f32 v155, v110, v111
  v_cvt_pk_bf16_f32 v156, v112, v113
  v_cvt_pk_bf16_f32 v157, v114, v115
  v_cvt_pk_bf16_f32 v158, v116, v117
  v_cvt_pk_bf16_f32 v159, v118, v119
  v_permlane32_swap_b32 v152, v154
  v_permlane32_swap_b32 v153, v155
  v_permlane32_swap_b32 v156, v158
  v_permlane32_swap_b32 v157, v159
  v_pk_mul_f32 v[120:121], v[120:121], v[58:59]
  v_pk_mul_f32 v[122:123], v[122:123], v[58:59]
  v_pk_mul_f32 v[124:125], v[124:125], v[58:59]
  v_pk_mul_f32 v[126:127], v[126:127], v[58:59]
  v_pk_mul_f32 v[128:129], v[128:129], v[58:59]
  v_pk_mul_f32 v[130:131], v[130:131], v[58:59]
  v_pk_mul_f32 v[132:133], v[132:133], v[58:59]
  v_pk_mul_f32 v[134:135], v[134:135], v[58:59]
  v_cvt_pk_bf16_f32 v160, v120, v121
  v_cvt_pk_bf16_f32 v161, v122, v123
  v_cvt_pk_bf16_f32 v162, v124, v125
  v_cvt_pk_bf16_f32 v163, v126, v127
  v_cvt_pk_bf16_f32 v164, v128, v129
  v_cvt_pk_bf16_f32 v165, v130, v131
  v_cvt_pk_bf16_f32 v166, v132, v133
  v_cvt_pk_bf16_f32 v167, v134, v135
  v_permlane32_swap_b32 v160, v162
  v_permlane32_swap_b32 v161, v163
  v_permlane32_swap_b32 v164, v166
  v_permlane32_swap_b32 v165, v167
  s_cmp_eq_u32 s41, 1
  s_cbranch_scc1 L_afast_5
  s_add_u32 s32, s31, 0
  buffer_store_dwordx4 v[152:155], v4, s[12:15], s32 offen offset:0 sc1
  buffer_store_dwordx4 v[160:163], v4, s[12:15], s32 offen offset:512 sc1
  s_add_u32 s32, s31, 65536
  buffer_store_dwordx4 v[156:159], v4, s[12:15], s32 offen offset:0 sc1
  buffer_store_dwordx4 v[164:167], v4, s[12:15], s32 offen offset:512 sc1
  s_branch L_adone_6
L_afast_5:
  s_add_u32 s32, s31, 0
  buffer_store_dwordx4 v[152:155], v4, s[12:15], s32 offen offset:0
  buffer_store_dwordx4 v[160:163], v4, s[12:15], s32 offen offset:512
  s_add_u32 s32, s31, 65536
  buffer_store_dwordx4 v[156:159], v4, s[12:15], s32 offen offset:0
  buffer_store_dwordx4 v[164:167], v4, s[12:15], s32 offen offset:512
L_adone_6:
L_askip_4:
  s_waitcnt vmcnt(0)
  v_mov_b32 v5, 137472
  v_mov_b32 v6, 1
  s_mov_b64 exec, 1
  ds_add_rtn_u32 v7, v5, v6 offset:44
  ds_read_b32 v8, v5 offset:4
  s_waitcnt lgkmcnt(0)
  v_readfirstlane_b32 s35, v7
  s_nop 0
  s_cmp_lg_u32 s35, 3
  s_cbranch_scc1 L_a_nf
  s_lshl_b32 s29, s46, 7
  s_lshl_b32 s30, s19, 3
  s_add_u32 s29, s29, s30
  s_add_u32 s29, s29, s20
  s_lshl_b32 s29, s29, 6
  s_add_u32 s29, s29, 294912
  v_mov_b32 v6, s29
  s_cmp_eq_u32 s41, 1
  s_cbranch_scc1 L_a_f1f
  buffer_store_dword v8, v6, s[12:15], 0 offen sc1
  s_branch L_a_nf
L_a_f1f:
  buffer_store_dword v8, v6, s[12:15], 0 offen
L_a_nf:
  s_mov_b64 exec, -1
  s_and_b32 s29, s19, 2
  s_cmp_lt_u32 s19, 12
  s_cselect_b32 s29, s29, 0
  s_cmp_lt_u32 s20, 2
  s_cselect_b32 s29, 0, s29
  s_cmp_eq_u32 s29, 0
  s_cbranch_scc1 L_a_e2
  s_lshr_b32 s29, s19, 2
  s_lshl_b32 s29, s29, 8
  s_and_b32 s30, s19, 1
  s_lshl_b32 s30, s30, 7
  s_add_u32 s29, s29, s30
  s_lshl_b32 s30, s22, 6
  s_add_u32 s29, s29, s30
  v_add_u32 v60, s29, v2
  v_lshlrev_b32 v60, 4, v60
  v_mul_u32_u24 v61, 12288, v3
  v_add_u32 v60, v60, v61
  s_lshl_b32 s29, s20, 2
  s_lshl_b32 s30, s21, 1
  s_add_u32 s29, s29, s30
  s_add_u32 s29, s29, 0
  s_cmp_ge_u32 s29, 30
  s_cbranch_scc1 L_hskip_7
  s_cmp_lt_u32 s29, 10
  s_cbranch_scc1 L_hskip_7
  s_mul_i32 s32, s29, 26
  s_lshr_b32 s32, s32, 8
  s_add_u32 s32, s32, s46
  s_mul_i32 s32, s32, 40
  s_lshl_b32 s31, s29, 2
  s_add_u32 s31, s31, s32
  s_sub_u32 s31, s31, 80
  s_mul_i32 s31, s31, 12288
  s_add_u32 s31, s31, 13631488
  s_add_u32 s32, s31, 0
  buffer_store_dwordx4 v[136:139], v60, s[12:15], s32 offen offset:0 sc1
  buffer_store_dwordx4 v[144:147], v60, s[12:15], s32 offen offset:512 sc1
  s_add_u32 s32, s31, 24576
  buffer_store_dwordx4 v[140:143], v60, s[12:15], s32 offen offset:0 sc1
  buffer_store_dwordx4 v[148:151], v60, s[12:15], s32 offen offset:512 sc1
L_hskip_7:
  s_lshl_b32 s29, s20, 2
  s_lshl_b32 s30, s21, 1
  s_add_u32 s29, s29, s30
  s_add_u32 s29, s29, 1
  s_cmp_ge_u32 s29, 30
  s_cbranch_scc1 L_hskip_8
  s_cmp_lt_u32 s29, 10
  s_cbranch_scc1 L_hskip_8
  s_mul_i32 s32, s29, 26
  s_lshr_b32 s32, s32, 8
  s_add_u32 s32, s32, s46
  s_mul_i32 s32, s32, 40
  s_lshl_b32 s31, s29, 2
  s_add_u32 s31, s31, s32
  s_sub_u32 s31, s31, 80
  s_mul_i32 s31, s31, 12288
  s_add_u32 s31, s31, 13631488
  s_add_u32 s32, s31, 0
  buffer_store_dwordx4 v[152:155], v60, s[12:15], s32 offen offset:0 sc1
  buffer_store_dwordx4 v[160:163], v60, s[12:15], s32 offen offset:512 sc1
  s_add_u32 s32, s31, 24576
  buffer_store_dwordx4 v[156:159], v60, s[12:15], s32 offen offset:0 sc1
  buffer_store_dwordx4 v[164:167], v60, s[12:15], s32 offen offset:512 sc1
L_hskip_8:
  s_waitcnt vmcnt(0)
  v_mov_b32 v6, 1
  s_mov_b64 exec, 1
  ds_add_rtn_u32 v7, v5, v6 offset:52
  s_waitcnt lgkmcnt(0)
  v_readfirstlane_b32 s35, v7
  s_nop 0
  s_cmp_lg_u32 s35, 3
  s_cbranch_scc1 L_a_nh
  s_lshl_b32 s29, s46, 7
  s_lshl_b32 s30, s19, 3
  s_add_u32 s29, s29, s30
  s_add_u32 s29, s29, s20
  s_lshl_b32 s29, s29, 6
  s_add_u32 s29, s29, 311296
  v_mov_b32 v6, s29
  buffer_store_dword v8, v6, s[12:15], 0 offen sc1
L_a_nh:
  s_mov_b64 exec, -1
L_a_e2:
  s_waitcnt vmcnt(0)
  s_and_b32 s62, s18, 15
  s_lshl_b32 s29, s46, 4
  s_add_u32 s62, s62, s29
  s_lshr_b32 s63, s18, 4
  s_lshl_b32 s29, s47, 1
  s_add_u32 s63, s63, s29
  s_and_b32 s64, s62, 1
  s_mul_i32 s65, s62, 5
  s_lshr_b32 s65, s65, 1
  v_and_b32 v2, 31, v1
  v_lshrrev_b32 v3, 5, v1
  v_lshlrev_b32 v5, 2, v3
  v_sub_u32 v5, v2, v5
  v_mov_b32 v6, 0xf149f2ca
  v_mov_b32 v7, 0
  v_cmp_le_i32 vcc, 0, v5
  s_nop 1
  v_cndmask_b32 v108, v6, v7, vcc
  v_cndmask_b32 v124, v7, v6, vcc
  v_cmp_le_i32 vcc, 1, v5
  s_nop 1
  v_cndmask_b32 v109, v6, v7, vcc
  v_cndmask_b32 v125, v7, v6, vcc
  v_cmp_le_i32 vcc, 2, v5
  s_nop 1
  v_cndmask_b32 v110, v6, v7, vcc
  v_cndmask_b32 v126, v7, v6, vcc
  v_cmp_le_i32 vcc, 3, v5
  s_nop 1
  v_cndmask_b32 v111, v6, v7, vcc
  v_cndmask_b32 v127, v7, v6, vcc
  v_cmp_le_i32 vcc, 8, v5
  s_nop 1
  v_cndmask_b32 v112, v6, v7, vcc
  v_cndmask_b32 v128, v7, v6, vcc
  v_cmp_le_i32 vcc, 9, v5
  s_nop 1
  v_cndmask_b32 v113, v6, v7, vcc
  v_cndmask_b32 v129, v7, v6, vcc
  v_cmp_le_i32 vcc, 10, v5
  s_nop 1
  v_cndmask_b32 v114, v6, v7, vcc
  v_cndmask_b32 v130, v7, v6, vcc
  v_cmp_le_i32 vcc, 11, v5
  s_nop 1
  v_cndmask_b32 v115, v6, v7, vcc
  v_cndmask_b32 v131, v7, v6, vcc
  v_cmp_le_i32 vcc, 16, v5
  s_nop 1
  v_cndmask_b32 v116, v6, v7, vcc
  v_cndmask_b32 v132, v7, v6, vcc
  v_cmp_le_i32 vcc, 17, v5
  s_nop 1
  v_cndmask_b32 v117, v6, v7, vcc
  v_cndmask_b32 v133, v7, v6, vcc
  v_cmp_le_i32 vcc, 18, v5
  s_nop 1
  v_cndmask_b32 v118, v6, v7, vcc
  v_cndmask_b32 v134, v7, v6, vcc
  v_cmp_le_i32 vcc, 19, v5
  s_nop 1
  v_cndmask_b32 v119, v6, v7, vcc
  v_cndmask_b32 v135, v7, v6, vcc
  v_cmp_le_i32 vcc, 24, v5
  s_nop 1
  v_cndmask_b32 v120, v6, v7, vcc
  v_cndmask_b32 v136, v7, v6, vcc
  v_cmp_le_i32 vcc, 25, v5
  s_nop 1
  v_cndmask_b32 v121, v6, v7, vcc
  v_cndmask_b32 v137, v7, v6, vcc
  v_cmp_le_i32 vcc, 26, v5
  s_nop 1
  v_cndmask_b32 v122, v6, v7, vcc
  v_cndmask_b32 v138, v7, v6, vcc
  v_cmp_le_i32 vcc, 27, v5
  s_nop 1
  v_cndmask_b32 v123, v6, v7, vcc
  v_cndmask_b32 v139, v7, v6, vcc
  s_lshl_b32 s29, s16, 9
  v_add_u32 v5, s64, v3
  v_mul_u32_u24 v5, 8256, v5
  v_lshl_add_u32 v16, v2, 4, v5
  v_add_u32 v16, s29, v16
  s_sub_u32 s30, 1, s64
  s_mul_i32 s30, s30, 16512
  s_add_u32 s30, s30, s29
  v_lshl_add_u32 v17, v2, 4, s30
  v_bfe_u32 v5, v1, 4, 1
  v_and_b32 v6, 3, v1
  v_lshl_add_u32 v5, v5, 2, v6
  v_add_u32 v6, s64, v5
  s_mul_i32 s30, s64, 6
  v_subrev_u32 v7, s30, v6
  v_cmp_eq_u32 vcc, 5, v5
  s_nop 1
  v_cndmask_b32 v6, v6, v7, vcc
  v_lshrrev_b32 v7, 1, v6
  v_mul_u32_u24 v7, 8256, v7
  v_and_b32 v6, 1, v6
  v_lshl_add_u32 v7, v6, 3, v7
  v_and_b32 v6, 1, v5
  v_lshlrev_b32 v6, 3, v6
  v_add_u32 v6, 192, v6
  v_cmp_lt_u32 vcc, 5, v5
  s_nop 1
  v_cndmask_b32 v7, v7, v6, vcc
  v_bfe_u32 v6, v1, 2, 2
  v_lshl_add_u32 v6, v3, 2, v6
  v_lshl_add_u32 v7, v6, 4, v7
  s_add_u32 s30, s29, 24768
  v_add_u32 v18, s30, v7
  s_and_b32 s67, s18, 7
  s_lshr_b32 s68, s18, 3
  s_mul_i32 s69, s67, 160
  s_and_b32 s29, s16, 3
  s_lshl_b32 s29, s29, 4
  s_lshl_b32 s30, s17, 8
  s_add_u32 s29, s29, s30
  s_lshl_b32 s30, s68, 6
  s_add_u32 s29, s29, s30
  v_and_b32 v19, 15, v1
  v_add_u32 v163, s29, v19
  v_mul_u32_u24 v162, 1280, v163
  v_lshrrev_b32 v19, 4, v1
  v_lshl_add_u32 v162, v19, 3, v162
  s_lshr_b32 s29, s16, 2
  s_mul_i32 s29, s29, 96
  s_add_u32 s29, s29, s69
  v_add_u32 v162, s29, v162
  buffer_load_dwordx2 v[154:155], v162, s[4:7], 0 offen offset:0
  buffer_load_dwordx2 v[156:157], v162, s[4:7], 0 offen offset:32
  buffer_load_dwordx2 v[158:159], v162, s[4:7], 0 offen offset:64
  v_lshlrev_b32 v19, 4, v163
  buffer_load_dwordx2 v[160:161], v19, s[12:15], 0 offen sc1
  s_lshl_b32 s34, s63, 8
  s_lshl_b32 s35, s16, 5
  s_add_u32 s34, s34, s35
  s_lshl_b32 s29, s16, 9
  s_add_u32 s29, s29, 107008
  v_add_u32 v5, s64, v3
  v_lshlrev_b32 v5, 12, v5
  v_lshl_add_u32 v5, v2, 4, v5
  v_add_u32 v6, s29, v5
  s_sub_u32 s30, 1, s64
  s_lshl_b32 s30, s30, 13
  s_add_u32 s30, s30, s29
  v_lshl_add_u32 v7, v2, 4, s30
  v_mov_b32 v5, 137472
L_spin_9:
  ds_read_b32 v19, v5 offset:8
  s_waitcnt lgkmcnt(0)
  v_readfirstlane_b32 s35, v19
  s_nop 0
  s_cmp_ge_u32 s35, 2
  s_cbranch_scc1 L_spino_10
  s_add_u32 s100, s100, 1
  s_bitcmp1_b32 s100, 21
  s_cbranch_scc0 L_spin_9
L_spino_10:
  ds_read_b128 v[8:11], v6
  ds_read_b128 v[12:15], v7
  s_waitcnt lgkmcnt(0)
  v_mov_b32 v6, 1
  s_mov_b64 exec, 1
  ds_add_u32 v5, v6 offset:40
  s_mov_b64 exec, -1
  v_cmp_gt_u32 vcc, 32, v1
  v_mov_b32 v5, 0
  v_mov_b32 v6, 0x3f80
  s_cmp_eq_u32 s64, 1
  s_cbranch_scc1 L_b_qodd
  v_cndmask_b32 v12, v5, v12, vcc
  v_cndmask_b32 v13, v5, v13, vcc
  v_mov_b32 v14, 0
  v_cndmask_b32 v15, v5, v6, vcc
  s_branch L_b_qd
L_b_qodd:
  v_mov_b32 v12, 0
  v_cndmask_b32 v13, v5, v6, vcc
  v_cndmask_b32 v14, v5, v14, vcc
  v_cndmask_b32 v15, v5, v15, vcc
L_b_qd:
  ds_read_b128 v[20:23], v16 offset:0
  ds_read_b128 v[24:27], v17 offset:0
  ds_read_b128 v[28:31], v16 offset:512
  ds_read_b128 v[32:35], v17 offset:512
  s_waitcnt lgkmcnt(2)
  v_mfma_f32_32x32x16_bf16 v[52:67], v[20:23], v[8:11], v[124:139]
  v_mfma_f32_32x32x16_bf16 v[52:67], v[24:27], v[12:15], v[52:67]
  ds_read_b128 v[20:23], v16 offset:1024
  ds_read_b128 v[24:27], v17 offset:1024
  s_waitcnt lgkmcnt(2)
  v_mfma_f32_32x32x16_bf16 v[68:83], v[28:31], v[8:11], 0
  v_mfma_f32_32x32x16_bf16 v[68:83], v[32:35], v[12:15], v[68:83]
  ds_read_b128 v[28:31], v16 offset:1536
  ds_read_b128 v[32:35], v17 offset:1536
  s_nop 4
  v_max_f32 v140, v52, v53
  v_max_f32 v141, v54, v55
  v_max3_f32 v140, v56, v57, v140
  v_max3_f32 v141, v58, v59, v141
  v_max3_f32 v140, v60, v61, v140
  v_max3_f32 v141, v62, v63, v141
  v_max3_f32 v140, v64, v65, v140
  v_max3_f32 v141, v66, v67, v141
  s_waitcnt lgkmcnt(2)
  v_mfma_f32_32x32x16_bf16 v[52:67], v[20:23], v[8:11], 0
  v_mfma_f32_32x32x16_bf16 v[52:67], v[24:27], v[12:15], v[52:67]
  ds_read_b128 v[20:23], v16 offset:2048
  ds_read_b128 v[24:27], v17 offset:2048
  v_max3_f32 v140, v68, v69, v140
  v_max3_f32 v141, v70, v71, v141
  v_max3_f32 v140, v72, v73, v140
  v_max3_f32 v141, v74, v75, v141
  v_max3_f32 v140, v76, v77, v140
  v_max3_f32 v141, v78, v79, v141
  v_max3_f32 v140, v80, v81, v140
  v_max3_f32 v141, v82, v83, v141
  s_waitcnt lgkmcnt(2)
  v_mfma_f32_32x32x16_bf16 v[68:83], v[28:31], v[8:11], 0
  v_mfma_f32_32x32x16_bf16 v[68:83], v[32:35], v[12:15], v[68:83]
  ds_read_b128 v[28:31], v16 offset:2560
  ds_read_b128 v[32:35], v17 offset:2560
  v_max3_f32 v140, v52, v53, v140
  v_max3_f32 v141, v54, v55, v141
  v_max3_f32 v140, v56, v57, v140
  v_max3_f32 v141, v58, v59, v141
  v_max3_f32 v140, v60, v61, v140
  v_max3_f32 v141, v62, v63, v141
  v_max3_f32 v140, v64, v65, v140
  v_max3_f32 v141, v66, v67, v141
  s_waitcnt lgkmcnt(2)
  v_mfma_f32_32x32x16_bf16 v[52:67], v[20:23], v[8:11], 0
  v_mfma_f32_32x32x16_bf16 v[52:67], v[24:27], v[12:15], v[52:67]
  ds_read_b128 v[20:23], v16 offset:3072
  ds_read_b128 v[24:27], v17 offset:3072
  v_max3_f32 v140, v68, v69, v140
  v_max3_f32 v141, v70, v71, v141
  v_max3_f32 v140, v72, v73, v140
  v_max3_f32 v141, v74, v75, v141
  v_max3_f32 v140, v76, v77, v140
  v_max3_f32 v141, v78, v79, v141
  v_max3_f32 v140, v80, v81, v140
  v_max3_f32 v141, v82, v83, v141
  s_waitcnt lgkmcnt(2)
  v_mfma_f32_32x32x16_bf16 v[68:83], v[28:31], v[8:11], 0
  v_mfma_f32_32x32x16_bf16 v[68:83], v[32:35], v[12:15], v[68:83]
  ds_read_b128 v[28:31], v16 offset:3584
  ds_read_b128 v[32:35], v17 offset:3584
  v_max3_f32 v140, v52, v53, v140
  v_max3_f32 v141, v54, v55, v141
  v_max3_f32 v140, v56, v57, v140
  v_max3_f32 v141, v58, v59, v141
  v_max3_f32 v140, v60, v61, v140
  v_max3_f32 v141, v62, v63, v141
  v_max3_f32 v140, v64, v65, v140
  v_max3_f32 v141, v66, v67, v141
  s_waitcnt lgkmcnt(2)
  v_mfma_f32_32x32x16_bf16 v[52:67], v[20:23], v[8:11], 0
  v_mfma_f32_32x32x16_bf16 v[52:67], v[24:27], v[12:15], v[52:67]
  ds_read_b128 v[20:23], v16 offset:4096
  ds_read_b128 v[24:27], v17 offset:4096
  v_max3_f32 v140, v68, v69, v140
  v_max3_f32 v141, v70, v71, v141
  v_max3_f32 v140, v72, v73, v140
  v_max3_f32 v141, v74, v75, v141
  v_max3_f32 v140, v76, v77, v140
  v_max3_f32 v141, v78, v79, v141
  v_max3_f32 v140, v80, v81, v140
  v_max3_f32 v141, v82, v83, v141
  s_waitcnt lgkmcnt(2)
  v_mfma_f32_32x32x16_bf16 v[68:83], v[28:31], v[8:11], 0
  v_mfma_f32_32x32x16_bf16 v[68:83], v[32:35], v[12:15], v[68:83]
  ds_read_b128 v[28:31], v16 offset:512
  ds_read_b128 v[32:35], v17 offset:512
  v_max3_f32 v140, v52, v53, v140
  v_max3_f32 v141, v54, v55, v141
  v_max3_f32 v140, v56, v57, v140
  v_max3_f32 v141, v58, v59, v141
  v_max3_f32 v140, v60, v61, v140
  v_max3_f32 v141, v62, v63, v141
  v_max3_f32 v140, v64, v65, v140
  v_max3_f32 v141, v66, v67, v141
  s_waitcnt lgkmcnt(2)
  v_mfma_f32_32x32x16_bf16 v[52:67], v[20:23], v[8:11], v[108:123]
  v_mfma_f32_32x32x16_bf16 v[52:67], v[24:27], v[12:15], v[52:67]
  ds_read_b128 v[20:23], v16 offset:0
  ds_read_b128 v[24:27], v17 offset:0
  ds_read_b64_tr_b16 v[36:37], v18 offset:0
  ds_read_b64_tr_b16 v[38:39], v18 offset:128
  ds_read_b64_tr_b16 v[40:41], v18 offset:256
  ds_read_b64_tr_b16 v[42:43], v18 offset:384
  ds_read_b64_tr_b16 v[44:45], v18 offset:512
  ds_read_b64_tr_b16 v[46:47], v18 offset:640
  ds_read_b64_tr_b16 v[48:49], v18 offset:768
  ds_read_b64_tr_b16 v[50:51], v18 offset:896
  v_max3_f32 v140, v68, v69, v140
  v_max3_f32 v141, v70, v71, v141
  v_max3_f32 v140, v72, v73, v140
  v_max3_f32 v141, v74, v75, v141
  v_max3_f32 v140, v76, v77, v140
  v_max3_f32 v141, v78, v79, v141
  v_max3_f32 v140, v80, v81, v140
  v_max3_f32 v141, v82, v83, v141
  v_max3_f32 v140, v52, v53, v140
  v_max3_f32 v141, v54, v55, v141
  v_max3_f32 v140, v56, v57, v140
  v_max3_f32 v141, v58, v59, v141
  v_max3_f32 v140, v60, v61, v140
  v_max3_f32 v141, v62, v63, v141
  v_max3_f32 v140, v64, v65, v140
  v_max3_f32 v141, v66, v67, v141
  v_max_f32 v140, v140, v141
  v_mov_b32 v141, v140
  s_nop 1
  v_permlane32_swap_b32 v140, v141
  v_max_f32 v140, v140, v141
  v_sub_f32 v140, 0, v140
  v_cvt_pk_bf16_f32 v141, v140, v140
  v_lshlrev_b32 v141, 16, v141
  v_sub_f32 v141, v140, v141
  v_cvt_pk_bf16_f32 v141, v140, v141
  v_cmp_gt_u32 vcc, 32, v1
  v_mov_b32 v142, 0
  s_nop 0
  v_cndmask_b32 v141, v142, v141, vcc
  s_cmp_eq_u32 s64, 1
  s_cbranch_scc1 L_b_mo
  v_mov_b32 v14, v141
  s_branch L_b_md
L_b_mo:
  v_mov_b32 v12, v141
L_b_md:
  s_nop 1
  s_waitcnt lgkmcnt(8)
  v_mfma_f32_32x32x16_bf16 v[52:67], v[20:23], v[8:11], v[124:139]
  v_mfma_f32_32x32x16_bf16 v[52:67], v[24:27], v[12:15], v[52:67]
  ds_read_b128 v[20:23], v16 offset:1024
  ds_read_b128 v[24:27], v17 offset:1024
  s_waitcnt lgkmcnt(12)
  v_mfma_f32_32x32x16_bf16 v[68:83], v[28:31], v[8:11], 0
  s_nop 7
  v_exp_f32 v52, v52
  v_exp_f32 v53, v53
  v_exp_f32 v54, v54
  v_exp_f32 v55, v55
  v_mfma_f32_32x32x16_bf16 v[68:83], v[32:35], v[12:15], v[68:83]
  ds_read_b128 v[28:31], v16 offset:1536
  ds_read_b128 v[32:35], v17 offset:1536
  v_exp_f32 v56, v56
  v_exp_f32 v57, v57
  v_exp_f32 v58, v58
  v_exp_f32 v59, v59
  v_cvt_pk_bf16_f32 v84, v52, v53
  v_cvt_pk_bf16_f32 v85, v54, v55
  v_cvt_pk_bf16_f32 v86, v56, v57
  v_cvt_pk_bf16_f32 v87, v58, v59
  v_exp_f32 v60, v60
  v_exp_f32 v61, v61
  s_waitcnt lgkmcnt(8)
  v_mfma_f32_32x32x16_bf16 v[92:107], v[36:39], v[84:87], 0
  v_exp_f32 v62, v62
  v_exp_f32 v63, v63
  v_exp_f32 v64, v64
  v_exp_f32 v65, v65
  v_exp_f32 v66, v66
  v_exp_f32 v67, v67
  v_cvt_pk_bf16_f32 v88, v60, v61
  v_cvt_pk_bf16_f32 v89, v62, v63
  v_cvt_pk_bf16_f32 v90, v64, v65
  v_cvt_pk_bf16_f32 v91, v66, v67
  s_nop 1
  v_mfma_f32_32x32x16_bf16 v[92:107], v[40:43], v[88:91], v[92:107]
  ds_read_b64_tr_b16 v[36:37], v18 offset:1024
  ds_read_b64_tr_b16 v[38:39], v18 offset:1152
  ds_read_b64_tr_b16 v[40:41], v18 offset:1280
  ds_read_b64_tr_b16 v[42:43], v18 offset:1408
  s_waitcnt lgkmcnt(6)
  v_mfma_f32_32x32x16_bf16 v[52:67], v[20:23], v[8:11], 0
  v_exp_f32 v68, v68
  v_exp_f32 v69, v69
  v_exp_f32 v70, v70
  v_exp_f32 v71, v71
  v_mfma_f32_32x32x16_bf16 v[52:67], v[24:27], v[12:15], v[52:67]
  ds_read_b128 v[20:23], v16 offset:2048
  ds_read_b128 v[24:27], v17 offset:2048
  v_exp_f32 v72, v72
  v_exp_f32 v73, v73
  v_exp_f32 v74, v74
  v_exp_f32 v75, v75
  v_cvt_pk_bf16_f32 v84, v68, v69
  v_cvt_pk_bf16_f32 v85, v70, v71
  v_cvt_pk_bf16_f32 v86, v72, v73
  v_cvt_pk_bf16_f32 v87, v74, v75
  v_exp_f32 v76, v76
  v_exp_f32 v77, v77
  s_waitcnt lgkmcnt(10)
  v_mfma_f32_32x32x16_bf16 v[92:107], v[44:47], v[84:87], v[92:107]
  v_exp_f32 v78, v78
  v_exp_f32 v79, v79
  v_exp_f32 v80, v80
  v_exp_f32 v81, v81
  v_exp_f32 v82, v82
  v_exp_f32 v83, v83
  v_cvt_pk_bf16_f32 v88, v76, v77
  v_cvt_pk_bf16_f32 v89, v78, v79
  v_cvt_pk_bf16_f32 v90, v80, v81
  v_cvt_pk_bf16_f32 v91, v82, v83
  s_nop 1
  v_mfma_f32_32x32x16_bf16 v[92:107], v[48:51], v[88:91], v[92:107]
  ds_read_b64_tr_b16 v[44:45], v18 offset:1536
  ds_read_b64_tr_b16 v[46:47], v18 offset:1664
  ds_read_b64_tr_b16 v[48:49], v18 offset:1792
  ds_read_b64_tr_b16 v[50:51], v18 offset:1920
  s_waitcnt lgkmcnt(10)
  v_mfma_f32_32x32x16_bf16 v[68:83], v[28:31], v[8:11], 0
  v_exp_f32 v52, v52
  v_exp_f32 v53, v53
  v_exp_f32 v54, v54
  v_exp_f32 v55, v55
  v_mfma_f32_32x32x16_bf16 v[68:83], v[32:35], v[12:15], v[68:83]
  ds_read_b128 v[28:31], v16 offset:2560
  ds_read_b128 v[32:35], v17 offset:2560
  v_exp_f32 v56, v56
  v_exp_f32 v57, v57
  v_exp_f32 v58, v58
  v_exp_f32 v59, v59
  v_cvt_pk_bf16_f32 v84, v52, v53
  v_cvt_pk_bf16_f32 v85, v54, v55
  v_cvt_pk_bf16_f32 v86, v56, v57
  v_cvt_pk_bf16_f32 v87, v58, v59
  v_exp_f32 v60, v60
  v_exp_f32 v61, v61
  s_waitcnt lgkmcnt(8)
  v_mfma_f32_32x32x16_bf16 v[92:107], v[36:39], v[84:87], v[92:107]
  v_exp_f32 v62, v62
  v_exp_f32 v63, v63
  v_exp_f32 v64, v64
  v_exp_f32 v65, v65
  v_exp_f32 v66, v66
  v_exp_f32 v67, v67
  v_cvt_pk_bf16_f32 v88, v60, v61
  v_cvt_pk_bf16_f32 v89, v62, v63
  v_cvt_pk_bf16_f32 v90, v64, v65
  v_cvt_pk_bf16_f32 v91, v66, v67
  s_nop 1
  v_mfma_f32_32x32x16_bf16 v[92:107], v[40:43], v[88:91], v[92:107]
  ds_read_b64_tr_b16 v[36:37], v18 offset:2048
  ds_read_b64_tr_b16 v[38:39], v18 offset:2176
  ds_read_b64_tr_b16 v[40:41], v18 offset:2304
  ds_read_b64_tr_b16 v[42:43], v18 offset:2432
  s_waitcnt lgkmcnt(10)
  v_mfma_f32_32x32x16_bf16 v[52:67], v[20:23], v[8:11], 0
  v_exp_f32 v68, v68
  v_exp_f32 v69, v69
  v_exp_f32 v70, v70
  v_exp_f32 v71, v71
  v_mfma_f32_32x32x16_bf16 v[52:67], v[24:27], v[12:15], v[52:67]
  ds_read_b128 v[20:23], v16 offset:3072
  ds_read_b128 v[24:27], v17 offset:3072
  v_exp_f32 v72, v72
  v_exp_f32 v73, v73
  v_exp_f32 v74, v74
  v_exp_f32 v75, v75
  v_cvt_pk_bf16_f32 v84, v68, v69
  v_cvt_pk_bf16_f32 v85, v70, v71
  v_cvt_pk_bf16_f32 v86, v72, v73
  v_cvt_pk_bf16_f32 v87, v74, v75
  v_exp_f32 v76, v76
  v_exp_f32 v77, v77
  s_waitcnt lgkmcnt(8)
  v_mfma_f32_32x32x16_bf16 v[92:107], v[44:47], v[84:87], v[92:107]
  v_exp_f32 v78, v78
  v_exp_f32 v79, v79
  v_exp_f32 v80, v80
  v_exp_f32 v81, v81
  v_exp_f32 v82, v82
  v_exp_f32 v83, v83
  v_cvt_pk_bf16_f32 v88, v76, v77
  v_cvt_pk_bf16_f32 v89, v78, v79
  v_cvt_pk_bf16_f32 v90, v80, v81
  v_cvt_pk_bf16_f32 v91, v82, v83
  s_nop 1
  v_mfma_f32_32x32x16_bf16 v[92:107], v[48:51], v[88:91], v[92:107]
  ds_read_b64_tr_b16 v[44:45], v18 offset:2560
  ds_read_b64_tr_b16 v[46:47], v18 offset:2688
  ds_read_b64_tr_b16 v[48:49], v18 offset:2816
  ds_read_b64_tr_b16 v[50:51], v18 offset:2944
  s_waitcnt lgkmcnt(10)
  v_mfma_f32_32x32x16_bf16 v[68:83], v[28:31], v[8:11], 0
  v_exp_f32 v52, v52
  v_exp_f32 v53, v53
  v_exp_f32 v54, v54
  v_exp_f32 v55, v55
  v_mfma_f32_32x32x16_bf16 v[68:83], v[32:35], v[12:15], v[68:83]
  ds_read_b128 v[28:31], v16 offset:3584
  ds_read_b128 v[32:35], v17 offset:3584
  v_exp_f32 v56, v56
  v_exp_f32 v57, v57
  v_exp_f32 v58, v58
  v_exp_f32 v59, v59
  v_cvt_pk_bf16_f32 v84, v52, v53
  v_cvt_pk_bf16_f32 v85, v54, v55
  v_cvt_pk_bf16_f32 v86, v56, v57
  v_cvt_pk_bf16_f32 v87, v58, v59
  v_exp_f32 v60, v60
  v_exp_f32 v61, v61
  s_waitcnt lgkmcnt(8)
  v_mfma_f32_32x32x16_bf16 v[92:107], v[36:39], v[84:87], v[92:107]
  v_exp_f32 v62, v62
  v_exp_f32 v63, v63
  v_exp_f32 v64, v64
  v_exp_f32 v65, v65
  v_exp_f32 v66, v66
  v_exp_f32 v67, v67
  v_cvt_pk_bf16_f32 v88, v60, v61
  v_cvt_pk_bf16_f32 v89, v62, v63
  v_cvt_pk_bf16_f32 v90, v64, v65
  v_cvt_pk_bf16_f32 v91, v66, v67
  s_nop 1
  v_mfma_f32_32x32x16_bf16 v[92:107], v[40:43], v[88:91], v[92:107]
  ds_read_b64_tr_b16 v[36:37], v18 offset:3072
  ds_read_b64_tr_b16 v[38:39], v18 offset:3200
  ds_read_b64_tr_b16 v[40:41], v18 offset:3328
  ds_read_b64_tr_b16 v[42:43], v18 offset:3456
  s_waitcnt lgkmcnt(10)
  v_mfma_f32_32x32x16_bf16 v[52:67], v[20:23], v[8:11], 0
  v_exp_f32 v68, v68
  v_exp_f32 v69, v69
  v_exp_f32 v70, v70
  v_exp_f32 v71, v71
  v_mfma_f32_32x32x16_bf16 v[52:67], v[24:27], v[12:15], v[52:67]
  ds_read_b128 v[20:23], v16 offset:4096
  ds_read_b128 v[24:27], v17 offset:4096
  v_exp_f32 v72, v72
  v_exp_f32 v73, v73
  v_exp_f32 v74, v74
  v_exp_f32 v75, v75
  v_cvt_pk_bf16_f32 v84, v68, v69
  v_cvt_pk_bf16_f32 v85, v70, v71
  v_cvt_pk_bf16_f32 v86, v72, v73
  v_cvt_pk_bf16_f32 v87, v74, v75
  v_exp_f32 v76, v76
  v_exp_f32 v77, v77
  s_waitcnt lgkmcnt(8)
  v_mfma_f32_32x32x16_bf16 v[92:107], v[44:47], v[84:87], v[92:107]
  v_exp_f32 v78, v78
  v_exp_f32 v79, v79
  v_exp_f32 v80, v80
  v_exp_f32 v81, v81
  v_exp_f32 v82, v82
  v_exp_f32 v83, v83
  v_cvt_pk_bf16_f32 v88, v76, v77
  v_cvt_pk_bf16_f32 v89, v78, v79
  v_cvt_pk_bf16_f32 v90, v80, v81
  v_cvt_pk_bf16_f32 v91, v82, v83
  s_nop 1
  v_mfma_f32_32x32x16_bf16 v[92:107], v[48:51], v[88:91], v[92:107]
  ds_read_b64_tr_b16 v[44:45], v18 offset:3584
  ds_read_b64_tr_b16 v[46:47], v18 offset:3712
  ds_read_b64_tr_b16 v[48:49], v18 offset:3840
  ds_read_b64_tr_b16 v[50:51], v18 offset:3968
  s_waitcnt lgkmcnt(10)
  v_mfma_f32_32x32x16_bf16 v[68:83], v[28:31], v[8:11], 0
  v_exp_f32 v52, v52
  v_exp_f32 v53, v53
  v_exp_f32 v54, v54
  v_exp_f32 v55, v55
  v_mfma_f32_32x32x16_bf16 v[68:83], v[32:35], v[12:15], v[68:83]
  v_exp_f32 v56, v56
  v_exp_f32 v57, v57
  v_exp_f32 v58, v58
  v_exp_f32 v59, v59
  v_cvt_pk_bf16_f32 v84, v52, v53
  v_cvt_pk_bf16_f32 v85, v54, v55
  v_cvt_pk_bf16_f32 v86, v56, v57
  v_cvt_pk_bf16_f32 v87, v58, v59
  v_exp_f32 v60, v60
  v_exp_f32 v61, v61
  s_waitcnt lgkmcnt(6)
  v_mfma_f32_32x32x16_bf16 v[92:107], v[36:39], v[84:87], v[92:107]
  v_exp_f32 v62, v62
  v_exp_f32 v63, v63
  v_exp_f32 v64, v64
  v_exp_f32 v65, v65
  v_exp_f32 v66, v66
  v_exp_f32 v67, v67
  v_cvt_pk_bf16_f32 v88, v60, v61
  v_cvt_pk_bf16_f32 v89, v62, v63
  v_cvt_pk_bf16_f32 v90, v64, v65
  v_cvt_pk_bf16_f32 v91, v66, v67
  s_nop 1
  v_mfma_f32_32x32x16_bf16 v[92:107], v[40:43], v[88:91], v[92:107]
  ds_read_b64_tr_b16 v[36:37], v18 offset:4096
  ds_read_b64_tr_b16 v[38:39], v18 offset:4224
  ds_read_b64_tr_b16 v[40:41], v18 offset:4352
  ds_read_b64_tr_b16 v[42:43], v18 offset:4480
  s_waitcnt lgkmcnt(8)
  v_mfma_f32_32x32x16_bf16 v[52:67], v[20:23], v[8:11], v[108:123]
  v_exp_f32 v68, v68
  v_exp_f32 v69, v69
  v_exp_f32 v70, v70
  v_exp_f32 v71, v71
  v_mfma_f32_32x32x16_bf16 v[52:67], v[24:27], v[12:15], v[52:67]
  v_exp_f32 v72, v72
  v_exp_f32 v73, v73
  v_exp_f32 v74, v74
  v_exp_f32 v75, v75
  v_cvt_pk_bf16_f32 v84, v68, v69
  v_cvt_pk_bf16_f32 v85, v70, v71
  v_cvt_pk_bf16_f32 v86, v72, v73
  v_cvt_pk_bf16_f32 v87, v74, v75
  v_exp_f32 v76, v76
  v_exp_f32 v77, v77
  s_waitcnt lgkmcnt(4)
  v_mfma_f32_32x32x16_bf16 v[92:107], v[44:47], v[84:87], v[92:107]
  v_exp_f32 v78, v78
  v_exp_f32 v79, v79
  v_exp_f32 v80, v80
  v_exp_f32 v81, v81
  v_exp_f32 v82, v82
  v_exp_f32 v83, v83
  v_cvt_pk_bf16_f32 v88, v76, v77
  v_cvt_pk_bf16_f32 v89, v78, v79
  v_cvt_pk_bf16_f32 v90, v80, v81
  v_cvt_pk_bf16_f32 v91, v82, v83
  s_nop 1
  v_mfma_f32_32x32x16_bf16 v[92:107], v[48:51], v[88:91], v[92:107]
  v_exp_f32 v52, v52
  v_exp_f32 v53, v53
  v_exp_f32 v54, v54
  v_exp_f32 v55, v55
  v_exp_f32 v56, v56
  v_exp_f32 v57, v57
  v_exp_f32 v58, v58
  v_exp_f32 v59, v59
  v_cvt_pk_bf16_f32 v84, v52, v53
  v_cvt_pk_bf16_f32 v85, v54, v55
  v_cvt_pk_bf16_f32 v86, v56, v57
  v_cvt_pk_bf16_f32 v87, v58, v59
  v_exp_f32 v60, v60
  v_exp_f32 v61, v61
  s_waitcnt lgkmcnt(0)
  v_mfma_f32_32x32x16_bf16 v[92:107], v[36:39], v[84:87], v[92:107]
  v_exp_f32 v62, v62
  v_exp_f32 v63, v63
  v_exp_f32 v64, v64
  v_exp_f32 v65, v65
  v_exp_f32 v66, v66
  v_exp_f32 v67, v67
  v_cvt_pk_bf16_f32 v88, v60, v61
  v_cvt_pk_bf16_f32 v89, v62, v63
  v_cvt_pk_bf16_f32 v90, v64, v65
  v_cvt_pk_bf16_f32 v91, v66, v67
  s_nop 1
  v_mfma_f32_32x32x16_bf16 v[92:107], v[40:43], v[88:91], v[92:107]
  s_nop 11
  v_mov_b32 v140, v100
  v_mov_b32 v141, v100
  s_nop 1
  v_permlane32_swap_b32 v140, v141
  v_rcp_f32 v141, v141
  s_nop 0
  v_mul_f32 v92, v92, v141
  v_mul_f32 v93, v93, v141
  v_mul_f32 v94, v94, v141
  v_mul_f32 v95, v95, v141
  v_mul_f32 v96, v96, v141
  v_mul_f32 v97, v97, v141
  v_mul_f32 v98, v98, v141
  v_mul_f32 v99, v99, v141
  v_mul_f32 v100, v100, v141
  v_mul_f32 v101, v101, v141
  v_mul_f32 v102, v102, v141
  v_mul_f32 v103, v103, v141
  v_cvt_pk_bf16_f32 v84, v92, v93
  v_cvt_pk_bf16_f32 v85, v94, v95
  v_cvt_pk_bf16_f32 v86, v96, v97
  v_cvt_pk_bf16_f32 v87, v98, v99
  v_cvt_pk_bf16_f32 v88, v100, v101
  v_cvt_pk_bf16_f32 v89, v102, v103
  v_add_u32 v5, s34, v2
  v_lshlrev_b32 v5, 3, v5
  v_lshl_add_u32 v5, v3, 14, v5
  s_mul_i32 s35, s62, 81920
  s_add_u32 s35, s35, 9437184
  buffer_store_dwordx2 v[84:85], v5, s[12:15], s35 offen sc1
  s_add_u32 s35, s35, 32768
  buffer_store_dwordx2 v[86:87], v5, s[12:15], s35 offen sc1
  s_add_u32 s35, s35, 32768
  s_mov_b32 exec_hi, 0
  buffer_store_dwordx2 v[88:89], v5, s[12:15], s35 offen sc1
  s_mov_b64 exec, -1
  v_mov_b32 v5, 137472
  ds_read_b32 v7, v5 offset:4
  s_lshl_b32 s35, s63, 5
  s_add_u32 s35, s35, s62
  s_lshl_b32 s35, s35, 3
  s_add_u32 s35, s35, s16
  s_lshl_b32 s35, s35, 6
  s_add_u32 s35, s35, 12320768
  v_mov_b32 v6, s35
  s_waitcnt lgkmcnt(0)
  s_mov_b64 exec, 1
  buffer_store_dword v7, v6, s[12:15], 0 offen sc1
  v_mov_b32 v6, 1
  ds_add_u32 v5, v6 offset:12
  s_mov_b64 exec, -1
L_b_nf:
  s_load_dwordx2 s[56:57], s[0:1], 64
  s_and_b32 s21, s16, 3
  s_lshr_b32 s22, s16, 2
  v_and_b32 v2, 15, v1
  v_lshrrev_b32 v3, 4, v1
  v_mov_b32 v8, v163
  v_mov_b32 v10, v162
  v_mov_b32 v5, 137472
  s_mul_i32 s30, s22, 1310720
  s_add_u32 s30, s30, 9437184
  v_lshlrev_b32 v20, 3, v8
  v_lshl_add_u32 v20, v3, 15, v20
  v_bfe_u32 v21, v1, 2, 2
  v_lshrrev_b32 v22, 1, v21
  v_and_b32 v23, 1, v3
  v_lshl_or_b32 v22, v23, 1, v22
  v_lshl_add_u32 v23, v3, 3, v21
  v_and_b32 v24, 3, v1
  v_lshlrev_b32 v24, 3, v24
  v_lshlrev_b32 v25, 7, v23
  v_lshl_add_u32 v25, v22, 5, v25
  v_add_u32 v25, v25, v24
  s_mul_i32 s31, s22, 40960
  s_add_u32 s31, s31, 49664
  s_cmp_eq_u32 s22, 0
  s_cselect_b32 s32, 66048, 0
  v_xor_b32 v26, 0, v25
  v_add_u32 v28, s31, v26
  v_add_u32 v32, s32, v26
  v_xor_b32 v26, 32, v25
  v_add_u32 v29, s31, v26
  v_add_u32 v33, s32, v26
  v_xor_b32 v26, 64, v25
  v_add_u32 v30, s31, v26
  v_add_u32 v34, s32, v26
  v_xor_b32 v26, 96, v25
  v_add_u32 v31, s31, v26
  v_add_u32 v35, s32, v26
  v_and_b32 v26, 1, v3
  v_lshlrev_b32 v26, 2, v26
  s_mul_i32 s31, s22, 10240
  s_add_u32 s31, s31, 107008
  v_xor_b32 v27, 0, v26
  v_add_u32 v27, v27, v23
  v_lshl_add_u32 v27, v27, 5, v24
  v_add_u32 v36, s31, v27
  v_xor_b32 v27, 4, v26
  v_add_u32 v27, v27, v23
  v_lshl_add_u32 v27, v27, 5, v24
  v_add_u32 v37, s31, v27
  s_waitcnt lgkmcnt(0)
  s_mov_b32 s58, 2621440
  s_mov_b32 s59, 0x20000
  ds_read_b32 v6, v5 offset:4
  v_lshlrev_b32 v11, 4, v8
  s_waitcnt lgkmcnt(0)
L_c_st:
  v_cmp_ne_u32 vcc, v6, v161
  s_nop 0
  s_cbranch_vccz L_c_stok
  buffer_load_dwordx2 v[160:161], v11, s[12:15], 0 offen sc1
  s_waitcnt vmcnt(0)
  s_add_u32 s100, s100, 1
  s_bitcmp1_b32 s100, 21
  s_cbranch_scc0 L_c_st
L_c_stok:
  v_lshlrev_b32 v22, 16, v160
  v_and_b32 v23, 0xffff0000, v160
  v_rcp_f32 v23, v23
  v_lshlrev_b32 v40, 16, v154
  v_and_b32 v41, 0xffff0000, v154
  v_lshlrev_b32 v42, 16, v155
  v_and_b32 v43, 0xffff0000, v155
  v_sub_f32 v52, v40, v22
  v_sub_f32 v53, v41, v22
  v_cvt_pk_bf16_f32 v26, v52, v53
  v_lshlrev_b32 v52, 16, v26
  v_and_b32 v53, 0xffff0000, v26
  v_mul_f32 v52, v52, v23
  v_mul_f32 v53, v53, v23
  v_cvt_pk_bf16_f32 v26, v52, v53
  v_lshlrev_b32 v52, 16, v26
  v_and_b32 v53, 0xffff0000, v26
  v_sub_f32 v54, v42, v22
  v_sub_f32 v55, v43, v22
  v_cvt_pk_bf16_f32 v26, v54, v55
  v_lshlrev_b32 v54, 16, v26
  v_and_b32 v55, 0xffff0000, v26
  v_mul_f32 v54, v54, v23
  v_mul_f32 v55, v55, v23
  v_cvt_pk_bf16_f32 v26, v54, v55
  v_lshlrev_b32 v54, 16, v26
  v_and_b32 v55, 0xffff0000, v26
  v_lshlrev_b32 v44, 16, v156
  v_and_b32 v45, 0xffff0000, v156
  v_lshlrev_b32 v46, 16, v157
  v_and_b32 v47, 0xffff0000, v157
  v_sub_f32 v56, v44, v22
  v_sub_f32 v57, v45, v22
  v_cvt_pk_bf16_f32 v26, v56, v57
  v_lshlrev_b32 v56, 16, v26
  v_and_b32 v57, 0xffff0000, v26
  v_mul_f32 v56, v56, v23
  v_mul_f32 v57, v57, v23
  v_cvt_pk_bf16_f32 v26, v56, v57
  v_lshlrev_b32 v56, 16, v26
  v_and_b32 v57, 0xffff0000, v26
  v_sub_f32 v58, v46, v22
  v_sub_f32 v59, v47, v22
  v_cvt_pk_bf16_f32 v26, v58, v59
  v_lshlrev_b32 v58, 16, v26
  v_and_b32 v59, 0xffff0000, v26
  v_mul_f32 v58, v58, v23
  v_mul_f32 v59, v59, v23
  v_cvt_pk_bf16_f32 v26, v58, v59
  v_lshlrev_b32 v58, 16, v26
  v_and_b32 v59, 0xffff0000, v26
  v_lshlrev_b32 v48, 16, v158
  v_and_b32 v49, 0xffff0000, v158
  v_lshlrev_b32 v50, 16, v159
  v_and_b32 v51, 0xffff0000, v159
  v_sub_f32 v60, v48, v22
  v_sub_f32 v61, v49, v22
  v_cvt_pk_bf16_f32 v26, v60, v61
  v_lshlrev_b32 v60, 16, v26
  v_and_b32 v61, 0xffff0000, v26
  v_mul_f32 v60, v60, v23
  v_mul_f32 v61, v61, v23
  v_cvt_pk_bf16_f32 v26, v60, v61
  v_lshlrev_b32 v60, 16, v26
  v_and_b32 v61, 0xffff0000, v26
  v_sub_f32 v62, v50, v22
  v_sub_f32 v63, v51, v22
  v_cvt_pk_bf16_f32 v26, v62, v63
  v_lshlrev_b32 v62, 16, v26
  v_and_b32 v63, 0xffff0000, v26
  v_mul_f32 v62, v62, v23
  v_mul_f32 v63, v63, v23
  v_cvt_pk_bf16_f32 v26, v62, v63
  v_lshlrev_b32 v62, 16, v26
  v_and_b32 v63, 0xffff0000, v26
L_spin_11:
  ds_read_b32 v6, v5 offset:16
  s_waitcnt lgkmcnt(0)
  v_readfirstlane_b32 s35, v6
  s_nop 0
  s_cmp_ge_u32 s35, 1
  s_cbranch_scc1 L_spino_12
  s_add_u32 s100, s100, 1
  s_bitcmp1_b32 s100, 21
  s_cbranch_scc0 L_spin_11
L_spino_12:
L_c_retry:
  v_mov_b32 v38, 0
  s_add_u32 s31, s30, 0
  buffer_load_dwordx2 v[64:65], v20, s[12:15], s31 offen sc1
  s_add_u32 s31, s31, 16384
  buffer_load_dwordx2 v[66:67], v20, s[12:15], s31 offen sc1
  s_add_u32 s31, s30, 131072
  buffer_load_dwordx2 v[68:69], v20, s[12:15], s31 offen sc1
  s_add_u32 s31, s31, 16384
  buffer_load_dwordx2 v[70:71], v20, s[12:15], s31 offen sc1
  s_add_u32 s31, s30, 262144
  buffer_load_dwordx2 v[72:73], v20, s[12:15], s31 offen sc1
  s_add_u32 s31, s31, 16384
  buffer_load_dwordx2 v[74:75], v20, s[12:15], s31 offen sc1
  s_add_u32 s31, s30, 393216
  buffer_load_dwordx2 v[76:77], v20, s[12:15], s31 offen sc1
  s_add_u32 s31, s31, 16384
  buffer_load_dwordx2 v[78:79], v20, s[12:15], s31 offen sc1
  s_add_u32 s31, s30, 524288
  buffer_load_dwordx2 v[80:81], v20, s[12:15], s31 offen sc1
  s_add_u32 s31, s31, 16384
  buffer_load_dwordx2 v[82:83], v20, s[12:15], s31 offen sc1
  s_add_u32 s31, s30, 655360
  buffer_load_dwordx2 v[84:85], v20, s[12:15], s31 offen sc1
  s_add_u32 s31, s31, 16384
  buffer_load_dwordx2 v[86:87], v20, s[12:15], s31 offen sc1
  s_add_u32 s31, s30, 786432
  buffer_load_dwordx2 v[88:89], v20, s[12:15], s31 offen sc1
  s_add_u32 s31, s31, 16384
  buffer_load_dwordx2 v[90:91], v20, s[12:15], s31 offen sc1
  s_add_u32 s31, s30, 917504
  buffer_load_dwordx2 v[92:93], v20, s[12:15], s31 offen sc1
  s_add_u32 s31, s31, 16384
  buffer_load_dwordx2 v[94:95], v20, s[12:15], s31 offen sc1
  s_add_u32 s31, s30, 1048576
  buffer_load_dwordx2 v[96:97], v20, s[12:15], s31 offen sc1
  s_add_u32 s31, s31, 16384
  buffer_load_dwordx2 v[98:99], v20, s[12:15], s31 offen sc1
  s_add_u32 s31, s30, 1179648
  buffer_load_dwordx2 v[100:101], v20, s[12:15], s31 offen sc1
  s_add_u32 s31, s31, 16384
  buffer_load_dwordx2 v[102:103], v20, s[12:15], s31 offen sc1
L_spin_13:
  ds_read_b32 v6, v5 offset:32
  s_waitcnt lgkmcnt(0)
  v_readfirstlane_b32 s35, v6
  s_nop 0
  s_cmp_ge_u32 s35, 2
  s_cbranch_scc1 L_spino_14
  s_add_u32 s100, s100, 1
  s_bitcmp1_b32 s100, 21
  s_cbranch_scc0 L_spin_13
L_spino_14:
  ds_read_b64_tr_b16 v[104:105], v28 offset:0
  ds_read_b64_tr_b16 v[106:107], v28 offset:512
  ds_read_b64_tr_b16 v[108:109], v29 offset:0
  ds_read_b64_tr_b16 v[110:111], v29 offset:512
  ds_read_b64_tr_b16 v[112:113], v30 offset:0
  ds_read_b64_tr_b16 v[114:115], v30 offset:512
  ds_read_b64_tr_b16 v[116:117], v31 offset:0
  ds_read_b64_tr_b16 v[118:119], v31 offset:512
  ds_read_b64_tr_b16 v[120:121], v36 offset:0
  ds_read_b64_tr_b16 v[122:123], v37 offset:0
  ds_read_b64_tr_b16 v[124:125], v28 offset:4096
  ds_read_b64_tr_b16 v[126:127], v28 offset:4608
  ds_read_b64_tr_b16 v[128:129], v29 offset:4096
  ds_read_b64_tr_b16 v[130:131], v29 offset:4608
  ds_read_b64_tr_b16 v[132:133], v30 offset:4096
  ds_read_b64_tr_b16 v[134:135], v30 offset:4608
  ds_read_b64_tr_b16 v[136:137], v31 offset:4096
  ds_read_b64_tr_b16 v[138:139], v31 offset:4608
  ds_read_b64_tr_b16 v[140:141], v36 offset:1024
  ds_read_b64_tr_b16 v[142:143], v37 offset:1024
  s_waitcnt lgkmcnt(10)
  s_waitcnt vmcnt(18)
  v_mfma_f32_16x16x32_bf16 v[144:147], v[104:107], v[64:67], 0
  v_mfma_f32_16x16x32_bf16 v[148:151], v[108:111], v[64:67], 0
  v_mfma_f32_16x16x32_bf16 v[152:155], v[112:115], v[64:67], 0
  v_mfma_f32_16x16x32_bf16 v[156:159], v[116:119], v[64:67], 0
  v_mfma_f32_16x16x32_bf16 v[160:163], v[120:123], v[64:67], 0
  v_max3_u32 v38, v64, v65, v38
  v_max3_u32 v38, v66, v67, v38
  ds_read_b64_tr_b16 v[104:105], v28 offset:8192
  ds_read_b64_tr_b16 v[106:107], v28 offset:8704
  ds_read_b64_tr_b16 v[108:109], v29 offset:8192
  ds_read_b64_tr_b16 v[110:111], v29 offset:8704
  ds_read_b64_tr_b16 v[112:113], v30 offset:8192
  ds_read_b64_tr_b16 v[114:115], v30 offset:8704
  ds_read_b64_tr_b16 v[116:117], v31 offset:8192
  ds_read_b64_tr_b16 v[118:119], v31 offset:8704
  ds_read_b64_tr_b16 v[120:121], v36 offset:2048
  ds_read_b64_tr_b16 v[122:123], v37 offset:2048
  s_waitcnt lgkmcnt(10)
  s_waitcnt vmcnt(16)
  v_mfma_f32_16x16x32_bf16 v[144:147], v[124:127], v[68:71], v[144:147]
  v_mfma_f32_16x16x32_bf16 v[148:151], v[128:131], v[68:71], v[148:151]
  v_mfma_f32_16x16x32_bf16 v[152:155], v[132:135], v[68:71], v[152:155]
  v_mfma_f32_16x16x32_bf16 v[156:159], v[136:139], v[68:71], v[156:159]
  v_mfma_f32_16x16x32_bf16 v[160:163], v[140:143], v[68:71], v[160:163]
  v_max3_u32 v38, v68, v69, v38
  v_max3_u32 v38, v70, v71, v38
  ds_read_b64_tr_b16 v[124:125], v28 offset:12288
  ds_read_b64_tr_b16 v[126:127], v28 offset:12800
  ds_read_b64_tr_b16 v[128:129], v29 offset:12288
  ds_read_b64_tr_b16 v[130:131], v29 offset:12800
  ds_read_b64_tr_b16 v[132:133], v30 offset:12288
  ds_read_b64_tr_b16 v[134:135], v30 offset:12800
  ds_read_b64_tr_b16 v[136:137], v31 offset:12288
  ds_read_b64_tr_b16 v[138:139], v31 offset:12800
  ds_read_b64_tr_b16 v[140:141], v36 offset:3072
  ds_read_b64_tr_b16 v[142:143], v37 offset:3072
  s_waitcnt lgkmcnt(10)
  s_waitcnt vmcnt(14)
  v_mfma_f32_16x16x32_bf16 v[144:147], v[104:107], v[72:75], v[144:147]
  v_mfma_f32_16x16x32_bf16 v[148:151], v[108:111], v[72:75], v[148:151]
  v_mfma_f32_16x16x32_bf16 v[152:155], v[112:115], v[72:75], v[152:155]
  v_mfma_f32_16x16x32_bf16 v[156:159], v[116:119], v[72:75], v[156:159]
  v_mfma_f32_16x16x32_bf16 v[160:163], v[120:123], v[72:75], v[160:163]
  v_max3_u32 v38, v72, v73, v38
  v_max3_u32 v38, v74, v75, v38
  ds_read_b64_tr_b16 v[104:105], v32 offset:0
  ds_read_b64_tr_b16 v[106:107], v32 offset:512
  ds_read_b64_tr_b16 v[108:109], v33 offset:0
  ds_read_b64_tr_b16 v[110:111], v33 offset:512
  ds_read_b64_tr_b16 v[112:113], v34 offset:0
  ds_read_b64_tr_b16 v[114:115], v34 offset:512
  ds_read_b64_tr_b16 v[116:117], v35 offset:0
  ds_read_b64_tr_b16 v[118:119], v35 offset:512
  ds_read_b64_tr_b16 v[120:121], v36 offset:4096
  ds_read_b64_tr_b16 v[122:123], v37 offset:4096
  s_waitcnt lgkmcnt(10)
  s_waitcnt vmcnt(12)
  v_mfma_f32_16x16x32_bf16 v[144:147], v[124:127], v[76:79], v[144:147]
  v_mfma_f32_16x16x32_bf16 v[148:151], v[128:131], v[76:79], v[148:151]
  v_mfma_f32_16x16x32_bf16 v[152:155], v[132:135], v[76:79], v[152:155]
  v_mfma_f32_16x16x32_bf16 v[156:159], v[136:139], v[76:79], v[156:159]
  v_mfma_f32_16x16x32_bf16 v[160:163], v[140:143], v[76:79], v[160:163]
  v_max3_u32 v38, v76, v77, v38
  v_max3_u32 v38, v78, v79, v38
  ds_read_b64_tr_b16 v[124:125], v32 offset:4096
  ds_read_b64_tr_b16 v[126:127], v32 offset:4608
  ds_read_b64_tr_b16 v[128:129], v33 offset:4096
  ds_read_b64_tr_b16 v[130:131], v33 offset:4608
  ds_read_b64_tr_b16 v[132:133], v34 offset:4096
  ds_read_b64_tr_b16 v[134:135], v34 offset:4608
  ds_read_b64_tr_b16 v[136:137], v35 offset:4096
  ds_read_b64_tr_b16 v[138:139], v35 offset:4608
  ds_read_b64_tr_b16 v[140:141], v36 offset:5120
  ds_read_b64_tr_b16 v[142:143], v37 offset:5120
  s_waitcnt lgkmcnt(10)
  s_waitcnt vmcnt(10)
  v_mfma_f32_16x16x32_bf16 v[144:147], v[104:107], v[80:83], v[144:147]
  v_mfma_f32_16x16x32_bf16 v[148:151], v[108:111], v[80:83], v[148:151]
  v_mfma_f32_16x16x32_bf16 v[152:155], v[112:115], v[80:83], v[152:155]
  v_mfma_f32_16x16x32_bf16 v[156:159], v[116:119], v[80:83], v[156:159]
  v_mfma_f32_16x16x32_bf16 v[160:163], v[120:123], v[80:83], v[160:163]
  v_max3_u32 v38, v80, v81, v38
  v_max3_u32 v38, v82, v83, v38
  ds_read_b64_tr_b16 v[104:105], v32 offset:8192
  ds_read_b64_tr_b16 v[106:107], v32 offset:8704
  ds_read_b64_tr_b16 v[108:109], v33 offset:8192
  ds_read_b64_tr_b16 v[110:111], v33 offset:8704
  ds_read_b64_tr_b16 v[112:113], v34 offset:8192
  ds_read_b64_tr_b16 v[114:115], v34 offset:8704
  ds_read_b64_tr_b16 v[116:117], v35 offset:8192
  ds_read_b64_tr_b16 v[118:119], v35 offset:8704
  ds_read_b64_tr_b16 v[120:121], v36 offset:6144
  ds_read_b64_tr_b16 v[122:123], v37 offset:6144
  s_waitcnt lgkmcnt(10)
  s_waitcnt vmcnt(8)
  v_mfma_f32_16x16x32_bf16 v[144:147], v[124:127], v[84:87], v[144:147]
  v_mfma_f32_16x16x32_bf16 v[148:151], v[128:131], v[84:87], v[148:151]
  v_mfma_f32_16x16x32_bf16 v[152:155], v[132:135], v[84:87], v[152:155]
  v_mfma_f32_16x16x32_bf16 v[156:159], v[136:139], v[84:87], v[156:159]
  v_mfma_f32_16x16x32_bf16 v[160:163], v[140:143], v[84:87], v[160:163]
  v_max3_u32 v38, v84, v85, v38
  v_max3_u32 v38, v86, v87, v38
  ds_read_b64_tr_b16 v[124:125], v32 offset:12288
  ds_read_b64_tr_b16 v[126:127], v32 offset:12800
  ds_read_b64_tr_b16 v[128:129], v33 offset:12288
  ds_read_b64_tr_b16 v[130:131], v33 offset:12800
  ds_read_b64_tr_b16 v[132:133], v34 offset:12288
  ds_read_b64_tr_b16 v[134:135], v34 offset:12800
  ds_read_b64_tr_b16 v[136:137], v35 offset:12288
  ds_read_b64_tr_b16 v[138:139], v35 offset:12800
  ds_read_b64_tr_b16 v[140:141], v36 offset:7168
  ds_read_b64_tr_b16 v[142:143], v37 offset:7168
  s_waitcnt lgkmcnt(10)
  s_waitcnt vmcnt(6)
  v_mfma_f32_16x16x32_bf16 v[144:147], v[104:107], v[88:91], v[144:147]
  v_mfma_f32_16x16x32_bf16 v[148:151], v[108:111], v[88:91], v[148:151]
  v_mfma_f32_16x16x32_bf16 v[152:155], v[112:115], v[88:91], v[152:155]
  v_mfma_f32_16x16x32_bf16 v[156:159], v[116:119], v[88:91], v[156:159]
  v_mfma_f32_16x16x32_bf16 v[160:163], v[120:123], v[88:91], v[160:163]
  v_max3_u32 v38, v88, v89, v38
  v_max3_u32 v38, v90, v91, v38
  ds_read_b64_tr_b16 v[104:105], v32 offset:16384
  ds_read_b64_tr_b16 v[106:107], v32 offset:16896
  ds_read_b64_tr_b16 v[108:109], v33 offset:16384
  ds_read_b64_tr_b16 v[110:111], v33 offset:16896
  ds_read_b64_tr_b16 v[112:113], v34 offset:16384
  ds_read_b64_tr_b16 v[114:115], v34 offset:16896
  ds_read_b64_tr_b16 v[116:117], v35 offset:16384
  ds_read_b64_tr_b16 v[118:119], v35 offset:16896
  ds_read_b64_tr_b16 v[120:121], v36 offset:8192
  ds_read_b64_tr_b16 v[122:123], v37 offset:8192
  s_waitcnt lgkmcnt(10)
  s_waitcnt vmcnt(4)
  v_mfma_f32_16x16x32_bf16 v[144:147], v[124:127], v[92:95], v[144:147]
  v_mfma_f32_16x16x32_bf16 v[148:151], v[128:131], v[92:95], v[148:151]
  v_mfma_f32_16x16x32_bf16 v[152:155], v[132:135], v[92:95], v[152:155]
  v_mfma_f32_16x16x32_bf16 v[156:159], v[136:139], v[92:95], v[156:159]
  v_mfma_f32_16x16x32_bf16 v[160:163], v[140:143], v[92:95], v[160:163]
  v_max3_u32 v38, v92, v93, v38
  v_max3_u32 v38, v94, v95, v38
  ds_read_b64_tr_b16 v[124:125], v32 offset:20480
  ds_read_b64_tr_b16 v[126:127], v32 offset:20992
  ds_read_b64_tr_b16 v[128:129], v33 offset:20480
  ds_read_b64_tr_b16 v[130:131], v33 offset:20992
  ds_read_b64_tr_b16 v[132:133], v34 offset:20480
  ds_read_b64_tr_b16 v[134:135], v34 offset:20992
  ds_read_b64_tr_b16 v[136:137], v35 offset:20480
  ds_read_b64_tr_b16 v[138:139], v35 offset:20992
  ds_read_b64_tr_b16 v[140:141], v36 offset:9216
  ds_read_b64_tr_b16 v[142:143], v37 offset:9216
  s_waitcnt lgkmcnt(10)
  s_waitcnt vmcnt(2)
  v_mfma_f32_16x16x32_bf16 v[144:147], v[104:107], v[96:99], v[144:147]
  v_mfma_f32_16x16x32_bf16 v[148:151], v[108:111], v[96:99], v[148:151]
  v_mfma_f32_16x16x32_bf16 v[152:155], v[112:115], v[96:99], v[152:155]
  v_mfma_f32_16x16x32_bf16 v[156:159], v[116:119], v[96:99], v[156:159]
  v_mfma_f32_16x16x32_bf16 v[160:163], v[120:123], v[96:99], v[160:163]
  v_max3_u32 v38, v96, v97, v38
  v_max3_u32 v38, v98, v99, v38
  s_waitcnt lgkmcnt(0)
  s_waitcnt vmcnt(0)
  v_mfma_f32_16x16x32_bf16 v[144:147], v[124:127], v[100:103], v[144:147]
  v_mfma_f32_16x16x32_bf16 v[148:151], v[128:131], v[100:103], v[148:151]
  v_mfma_f32_16x16x32_bf16 v[152:155], v[132:135], v[100:103], v[152:155]
  v_mfma_f32_16x16x32_bf16 v[156:159], v[136:139], v[100:103], v[156:159]
  v_mfma_f32_16x16x32_bf16 v[160:163], v[140:143], v[100:103], v[160:163]
  v_max3_u32 v38, v100, v101, v38
  v_max3_u32 v38, v102, v103, v38
  v_cmp_eq_u32 vcc, -1, v38
  s_nop 0
  s_cbranch_vccz L_ok_15
  s_sleep 12
  s_add_u32 s100, s100, 1
  s_bitcmp1_b32 s100, 21
  s_cbranch_scc0 L_c_retry
L_ok_15:
  s_mul_i32 s29, s16, 3072
  s_add_u32 s29, s29, 24832
  v_lshlrev_b32 v26, 4, v1
  v_add_u32 v26, s29, v26
  s_cmp_eq_u32 s22, 0
  s_cbranch_scc0 L_c_x1
  ds_write_b128 v26, v[156:159]
  ds_write_b128 v26, v[160:163] offset:1024
  s_branch L_c_x2
L_c_x1:
  ds_write_b128 v26, v[144:147]
  ds_write_b128 v26, v[148:151] offset:1024
  ds_write_b128 v26, v[152:155] offset:2048
  v_mov_b32 v144, v156
  v_mov_b32 v145, v157
  v_mov_b32 v146, v158
  v_mov_b32 v147, v159
  v_mov_b32 v148, v160
  v_mov_b32 v149, v161
  v_mov_b32 v150, v162
  v_mov_b32 v151, v163
L_c_x2:
  s_lshl_b32 s29, s16, 2
  s_add_u32 s29, s29, 137536
  v_mov_b32 v27, s29
  v_mov_b32 v6, 1
  s_waitcnt lgkmcnt(0)
  s_mov_b64 exec, 1
  ds_write_b32 v27, v6
  s_mov_b64 exec, -1
  s_xor_b32 s31, s16, 4
  s_lshl_b32 s29, s31, 2
  s_add_u32 s29, s29, 137536
  v_mov_b32 v27, s29
L_spin_16:
  ds_read_b32 v6, v27 offset:0
  s_waitcnt lgkmcnt(0)
  v_readfirstlane_b32 s35, v6
  s_nop 0
  s_cmp_ge_u32 s35, 1
  s_cbranch_scc1 L_spino_17
  s_add_u32 s100, s100, 1
  s_bitcmp1_b32 s100, 21
  s_cbranch_scc0 L_spin_16
L_spino_17:
  s_mul_i32 s29, s31, 3072
  s_add_u32 s29, s29, 24832
  v_lshlrev_b32 v26, 4, v1
  v_add_u32 v26, s29, v26
  ds_read_b128 v[104:107], v26
  ds_read_b128 v[108:111], v26 offset:1024
  ds_read_b128 v[112:115], v26 offset:2048
  s_waitcnt lgkmcnt(0)
  v_add_f32 v144, v144, v104
  v_add_f32 v145, v145, v105
  v_add_f32 v146, v146, v106
  v_add_f32 v147, v147, v107
  v_add_f32 v148, v148, v108
  v_add_f32 v149, v149, v109
  v_add_f32 v150, v150, v110
  v_add_f32 v151, v151, v111
  v_add_f32 v152, v152, v112
  v_add_f32 v153, v153, v113
  v_add_f32 v154, v154, v114
  v_add_f32 v155, v155, v115
L_spin_18:
  ds_read_b32 v6, v5 offset:20
  s_waitcnt lgkmcnt(0)
  v_readfirstlane_b32 s35, v6
  s_nop 0
  s_cmp_ge_u32 s35, 1
  s_cbranch_scc1 L_spino_19
  s_add_u32 s100, s100, 1
  s_bitcmp1_b32 s100, 21
  s_cbranch_scc0 L_spin_18
L_spino_19:
  ds_read_b64 v[26:27], v5 offset:24
  ds_read_b32 v6, v5 offset:4
  s_waitcnt lgkmcnt(0)
  v_cmp_eq_u32 s[30:31], v26, v8
  v_cmp_eq_u32 s[32:33], v27, v8
  s_nop 0
  s_or_b64 s[34:35], s[30:31], s[32:33]
  s_cmp_eq_u64 s[34:35], 0
  s_cbranch_scc1 L_c_nomoe
  s_lshl_b32 s29, s69, 2
  s_mul_i32 s36, s22, 384
  s_add_u32 s29, s29, s36
  s_add_u32 s29, s29, 348160
  v_lshlrev_b32 v7, 5, v3
L_c_upd:
  buffer_load_dwordx4 v[104:107], v7, s[12:15], s29 offen offset:0 sc1
  buffer_load_dwordx4 v[108:111], v7, s[12:15], s29 offen offset:16 sc1
  buffer_load_dwordx4 v[112:115], v7, s[12:15], s29 offen offset:128 sc1
  buffer_load_dwordx4 v[116:119], v7, s[12:15], s29 offen offset:144 sc1
  buffer_load_dwordx4 v[120:123], v7, s[12:15], s29 offen offset:256 sc1
  buffer_load_dwordx4 v[124:127], v7, s[12:15], s29 offen offset:272 sc1
  s_waitcnt vmcnt(0)
  v_cmp_ne_u32 vcc, v6, v105
  v_cmp_ne_u32 s[36:37], v6, v107
  s_nop 0
  s_or_b64 vcc, vcc, s[36:37]
  v_cmp_ne_u32 s[36:37], v6, v109
  s_nop 0
  s_or_b64 vcc, vcc, s[36:37]
  v_cmp_ne_u32 s[36:37], v6, v111
  s_nop 0
  s_or_b64 vcc, vcc, s[36:37]
  v_cmp_ne_u32 s[36:37], v6, v113
  s_nop 0
  s_or_b64 vcc, vcc, s[36:37]
  v_cmp_ne_u32 s[36:37], v6, v115
  s_nop 0
  s_or_b64 vcc, vcc, s[36:37]
  v_cmp_ne_u32 s[36:37], v6, v117
  s_nop 0
  s_or_b64 vcc, vcc, s[36:37]
  v_cmp_ne_u32 s[36:37], v6, v119
  s_nop 0
  s_or_b64 vcc, vcc, s[36:37]
  s_cmp_eq_u32 s22, 1
  s_cbranch_scc1 L_u3_20
  v_cmp_ne_u32 s[36:37], v6, v121
  s_nop 0
  s_or_b64 vcc, vcc, s[36:37]
  v_cmp_ne_u32 s[36:37], v6, v123
  s_nop 0
  s_or_b64 vcc, vcc, s[36:37]
  v_cmp_ne_u32 s[36:37], v6, v125
  s_nop 0
  s_or_b64 vcc, vcc, s[36:37]
  v_cmp_ne_u32 s[36:37], v6, v127
  s_nop 0
  s_or_b64 vcc, vcc, s[36:37]
L_u3_20:
  s_and_b64 vcc, vcc, s[34:35]
  s_cbranch_vccz L_c_upd_o
  s_add_u32 s100, s100, 1
  s_bitcmp1_b32 s100, 21
  s_cbranch_scc0 L_c_upd
L_c_upd_o:
  v_lshlrev_b32 v26, 16, v104
  v_and_b32 v27, 0xffff0000, v104
  v_cndmask_b32 v26, v27, v26, s[30:31]
  v_add_f32 v26, v52, v26
  v_cvt_pk_bf16_f32 v26, v26, v26
  v_lshlrev_b32 v26, 16, v26
  v_cndmask_b32 v52, v52, v26, s[34:35]
  v_lshlrev_b32 v26, 16, v106
  v_and_b32 v27, 0xffff0000, v106
  v_cndmask_b32 v26, v27, v26, s[30:31]
  v_add_f32 v26, v53, v26
  v_cvt_pk_bf16_f32 v26, v26, v26
  v_lshlrev_b32 v26, 16, v26
  v_cndmask_b32 v53, v53, v26, s[34:35]
  v_lshlrev_b32 v26, 16, v108
  v_and_b32 v27, 0xffff0000, v108
  v_cndmask_b32 v26, v27, v26, s[30:31]
  v_add_f32 v26, v54, v26
  v_cvt_pk_bf16_f32 v26, v26, v26
  v_lshlrev_b32 v26, 16, v26
  v_cndmask_b32 v54, v54, v26, s[34:35]
  v_lshlrev_b32 v26, 16, v110
  v_and_b32 v27, 0xffff0000, v110
  v_cndmask_b32 v26, v27, v26, s[30:31]
  v_add_f32 v26, v55, v26
  v_cvt_pk_bf16_f32 v26, v26, v26
  v_lshlrev_b32 v26, 16, v26
  v_cndmask_b32 v55, v55, v26, s[34:35]
  v_lshlrev_b32 v26, 16, v112
  v_and_b32 v27, 0xffff0000, v112
  v_cndmask_b32 v26, v27, v26, s[30:31]
  v_add_f32 v26, v56, v26
  v_cvt_pk_bf16_f32 v26, v26, v26
  v_lshlrev_b32 v26, 16, v26
  v_cndmask_b32 v56, v56, v26, s[34:35]
  v_lshlrev_b32 v26, 16, v114
  v_and_b32 v27, 0xffff0000, v114
  v_cndmask_b32 v26, v27, v26, s[30:31]
  v_add_f32 v26, v57, v26
  v_cvt_pk_bf16_f32 v26, v26, v26
  v_lshlrev_b32 v26, 16, v26
  v_cndmask_b32 v57, v57, v26, s[34:35]
  v_lshlrev_b32 v26, 16, v116
  v_and_b32 v27, 0xffff0000, v116
  v_cndmask_b32 v26, v27, v26, s[30:31]
  v_add_f32 v26, v58, v26
  v_cvt_pk_bf16_f32 v26, v26, v26
  v_lshlrev_b32 v26, 16, v26
  v_cndmask_b32 v58, v58, v26, s[34:35]
  v_lshlrev_b32 v26, 16, v118
  v_and_b32 v27, 0xffff0000, v118
  v_cndmask_b32 v26, v27, v26, s[30:31]
  v_add_f32 v26, v59, v26
  v_cvt_pk_bf16_f32 v26, v26, v26
  v_lshlrev_b32 v26, 16, v26
  v_cndmask_b32 v59, v59, v26, s[34:35]
  v_lshlrev_b32 v26, 16, v120
  v_and_b32 v27, 0xffff0000, v120
  v_cndmask_b32 v26, v27, v26, s[30:31]
  v_add_f32 v26, v60, v26
  v_cvt_pk_bf16_f32 v26, v26, v26
  v_lshlrev_b32 v26, 16, v26
  v_cndmask_b32 v60, v60, v26, s[34:35]
  v_lshlrev_b32 v26, 16, v122
  v_and_b32 v27, 0xffff0000, v122
  v_cndmask_b32 v26, v27, v26, s[30:31]
  v_add_f32 v26, v61, v26
  v_cvt_pk_bf16_f32 v26, v26, v26
  v_lshlrev_b32 v26, 16, v26
  v_cndmask_b32 v61, v61, v26, s[34:35]
  v_lshlrev_b32 v26, 16, v124
  v_and_b32 v27, 0xffff0000, v124
  v_cndmask_b32 v26, v27, v26, s[30:31]
  v_add_f32 v26, v62, v26
  v_cvt_pk_bf16_f32 v26, v26, v26
  v_lshlrev_b32 v26, 16, v26
  v_cndmask_b32 v62, v62, v26, s[34:35]
  v_lshlrev_b32 v26, 16, v126
  v_and_b32 v27, 0xffff0000, v126
  v_cndmask_b32 v26, v27, v26, s[30:31]
  v_add_f32 v26, v63, v26
  v_cvt_pk_bf16_f32 v26, v26, v26
  v_lshlrev_b32 v26, 16, v26
  v_cndmask_b32 v63, v63, v26, s[34:35]
L_c_nomoe:
  v_cvt_pk_bf16_f32 v26, v144, v145
  v_lshlrev_b32 v144, 16, v26
  v_and_b32 v145, 0xffff0000, v26
  v_add_f32 v144, v144, v40
  v_add_f32 v145, v145, v41
  v_cvt_pk_bf16_f32 v26, v144, v145
  v_lshlrev_b32 v144, 16, v26
  v_and_b32 v145, 0xffff0000, v26
  v_add_f32 v144, v144, v52
  v_add_f32 v145, v145, v53
  v_cvt_pk_bf16_f32 v104, v144, v145
  v_cvt_pk_bf16_f32 v26, v146, v147
  v_lshlrev_b32 v146, 16, v26
  v_and_b32 v147, 0xffff0000, v26
  v_add_f32 v146, v146, v42
  v_add_f32 v147, v147, v43
  v_cvt_pk_bf16_f32 v26, v146, v147
  v_lshlrev_b32 v146, 16, v26
  v_and_b32 v147, 0xffff0000, v26
  v_add_f32 v146, v146, v54
  v_add_f32 v147, v147, v55
  v_cvt_pk_bf16_f32 v105, v146, v147
  buffer_store_dwordx2 v[104:105], v10, s[56:59], 0 offen offset:0
  v_cvt_pk_bf16_f32 v26, v148, v149
  v_lshlrev_b32 v148, 16, v26
  v_and_b32 v149, 0xffff0000, v26
  v_add_f32 v148, v148, v44
  v_add_f32 v149, v149, v45
  v_cvt_pk_bf16_f32 v26, v148, v149
  v_lshlrev_b32 v148, 16, v26
  v_and_b32 v149, 0xffff0000, v26
  v_add_f32 v148, v148, v56
  v_add_f32 v149, v149, v57
  v_cvt_pk_bf16_f32 v106, v148, v149
  v_cvt_pk_bf16_f32 v26, v150, v151
  v_lshlrev_b32 v150, 16, v26
  v_and_b32 v151, 0xffff0000, v26
  v_add_f32 v150, v150, v46
  v_add_f32 v151, v151, v47
  v_cvt_pk_bf16_f32 v26, v150, v151
  v_lshlrev_b32 v150, 16, v26
  v_and_b32 v151, 0xffff0000, v26
  v_add_f32 v150, v150, v58
  v_add_f32 v151, v151, v59
  v_cvt_pk_bf16_f32 v107, v150, v151
  buffer_store_dwordx2 v[106:107], v10, s[56:59], 0 offen offset:32
  s_cmp_eq_u32 s22, 1
  s_cbranch_scc1 L_c_done
  v_cvt_pk_bf16_f32 v26, v152, v153
  v_lshlrev_b32 v152, 16, v26
  v_and_b32 v153, 0xffff0000, v26
  v_add_f32 v152, v152, v48
  v_add_f32 v153, v153, v49
  v_cvt_pk_bf16_f32 v26, v152, v153
  v_lshlrev_b32 v152, 16, v26
  v_and_b32 v153, 0xffff0000, v26
  v_add_f32 v152, v152, v60
  v_add_f32 v153, v153, v61
  v_cvt_pk_bf16_f32 v108, v152, v153
  v_cvt_pk_bf16_f32 v26, v154, v155
  v_lshlrev_b32 v154, 16, v26
  v_and_b32 v155, 0xffff0000, v26
  v_add_f32 v154, v154, v50
  v_add_f32 v155, v155, v51
  v_cvt_pk_bf16_f32 v26, v154, v155
  v_lshlrev_b32 v154, 16, v26
  v_and_b32 v155, 0xffff0000, v26
  v_add_f32 v154, v154, v62
  v_add_f32 v155, v155, v63
  v_cvt_pk_bf16_f32 v109, v154, v155
  buffer_store_dwordx2 v[108:109], v10, s[56:59], 0 offen offset:64
L_c_done:
  s_branch L_end
L_ln:
  s_sub_u32 s21, s16, 4
  v_and_b32 v2, 31, v1
  v_lshrrev_b32 v3, 5, v1
  s_lshl_b32 s23, s46, 3
  s_add_u32 s23, s23, s20
  s_lshl_b32 s23, s23, 3
  s_lshl_b32 s29, s21, 1
  s_add_u32 s23, s23, s29
  s_lshl_b32 s29, s19, 7
  s_add_u32 s23, s23, s29
  v_add_u32 v20, s23, v3
  v_mul_u32_u24 v4, 1280, v20
  v_lshl_add_u32 v4, v2, 3, v4
  v_lshlrev_b32 v5, 3, v2
  s_lshl_b32 s29, s21, 4
  s_add_u32 s29, s29, 133120
  v_lshl_add_u32 v21, v3, 3, s29
  s_lshr_b32 s29, s21, 1
  s_lshl_b32 s29, s29, 13
  s_and_b32 s30, s21, 1
  s_lshl_b32 s30, s30, 12
  s_add_u32 s29, s29, s30
  s_add_u32 s29, s29, 65536
  v_lshrrev_b32 v8, 4, v1
  v_lshlrev_b32 v9, 2, v8
  v_and_b32 v10, 15, v1
  v_xor_b32 v9, v9, v10
  v_lshlrev_b32 v9, 4, v9
  v_lshl_add_u32 v9, v8, 8, v9
  v_add_u32 v16, s29, v9
  s_mov_b32 s28, 0xffff0000
  s_mov_b32 s44, 0x3acccccd
  s_mov_b32 s45, 0x3727c5ac
  s_waitcnt lgkmcnt(0)
  s_barrier
  buffer_load_dwordx2 v[104:105], v4, s[4:7], 0 offen offset:0
  buffer_load_dwordx2 v[106:107], v4, s[4:7], 0 offen offset:256
  buffer_load_dwordx2 v[108:109], v4, s[4:7], 0 offen offset:512
  buffer_load_dwordx2 v[110:111], v4, s[4:7], 0 offen offset:768
  buffer_load_dwordx2 v[112:113], v4, s[4:7], 0 offen offset:1024
  buffer_load_dwordx2 v[114:115], v5, s[36:39], 0 offen offset:0
  buffer_load_dwordx2 v[116:117], v5, s[36:39], 0 offen offset:256
  buffer_load_dwordx2 v[118:119], v5, s[36:39], 0 offen offset:512
  buffer_load_dwordx2 v[120:121], v5, s[36:39], 0 offen offset:768
  buffer_load_dwordx2 v[122:123], v5, s[36:39], 0 offen offset:1024
  ds_read_b128 v[48:51], v16 offset:0
  ds_read_b128 v[52:55], v16 offset:1024
  ds_read_b128 v[56:59], v16 offset:2048
  ds_read_b128 v[60:63], v16 offset:3072
  s_waitcnt lgkmcnt(3)
  v_lshlrev_b32 v72, 16, v48
  v_and_b32 v73, s28, v48
  v_lshlrev_b32 v74, 16, v49
  v_and_b32 v75, s28, v49
  v_lshlrev_b32 v76, 16, v50
  v_and_b32 v77, s28, v50
  v_lshlrev_b32 v78, 16, v51
  v_and_b32 v79, s28, v51
  s_waitcnt lgkmcnt(2)
  v_lshlrev_b32 v64, 16, v52
  v_and_b32 v65, s28, v52
  v_add_f32 v72, v72, v64
  v_add_f32 v73, v73, v65
  v_lshlrev_b32 v66, 16, v53
  v_and_b32 v67, s28, v53
  v_add_f32 v74, v74, v66
  v_add_f32 v75, v75, v67
  v_lshlrev_b32 v64, 16, v54
  v_and_b32 v65, s28, v54
  v_add_f32 v76, v76, v64
  v_add_f32 v77, v77, v65
  v_lshlrev_b32 v66, 16, v55
  v_and_b32 v67, s28, v55
  v_add_f32 v78, v78, v66
  v_add_f32 v79, v79, v67
  s_waitcnt lgkmcnt(1)
  v_lshlrev_b32 v64, 16, v56
  v_and_b32 v65, s28, v56
  v_add_f32 v72, v72, v64
  v_add_f32 v73, v73, v65
  v_lshlrev_b32 v66, 16, v57
  v_and_b32 v67, s28, v57
  v_add_f32 v74, v74, v66
  v_add_f32 v75, v75, v67
  v_lshlrev_b32 v64, 16, v58
  v_and_b32 v65, s28, v58
  v_add_f32 v76, v76, v64
  v_add_f32 v77, v77, v65
  v_lshlrev_b32 v66, 16, v59
  v_and_b32 v67, s28, v59
  v_add_f32 v78, v78, v66
  v_add_f32 v79, v79, v67
  s_waitcnt lgkmcnt(0)
  v_lshlrev_b32 v64, 16, v60
  v_and_b32 v65, s28, v60
  v_add_f32 v72, v72, v64
  v_add_f32 v73, v73, v65
  v_lshlrev_b32 v66, 16, v61
  v_and_b32 v67, s28, v61
  v_add_f32 v74, v74, v66
  v_add_f32 v75, v75, v67
  v_lshlrev_b32 v64, 16, v62
  v_and_b32 v65, s28, v62
  v_add_f32 v76, v76, v64
  v_add_f32 v77, v77, v65
  v_lshlrev_b32 v66, 16, v63
  v_and_b32 v67, s28, v63
  v_add_f32 v78, v78, v66
  v_add_f32 v79, v79, v67
  s_barrier
  ds_read_b128 v[48:51], v16 offset:16384
  ds_read_b128 v[52:55], v16 offset:17408
  ds_read_b128 v[56:59], v16 offset:18432
  ds_read_b128 v[60:63], v16 offset:19456
  s_waitcnt lgkmcnt(3)
  v_lshlrev_b32 v64, 16, v48
  v_and_b32 v65, s28, v48
  v_add_f32 v72, v72, v64
  v_add_f32 v73, v73, v65
  v_lshlrev_b32 v66, 16, v49
  v_and_b32 v67, s28, v49
  v_add_f32 v74, v74, v66
  v_add_f32 v75, v75, v67
  v_lshlrev_b32 v64, 16, v50
  v_and_b32 v65, s28, v50
  v_add_f32 v76, v76, v64
  v_add_f32 v77, v77, v65
  v_lshlrev_b32 v66, 16, v51
  v_and_b32 v67, s28, v51
  v_add_f32 v78, v78, v66
  v_add_f32 v79, v79, v67
  s_waitcnt lgkmcnt(2)
  v_lshlrev_b32 v64, 16, v52
  v_and_b32 v65, s28, v52
  v_add_f32 v72, v72, v64
  v_add_f32 v73, v73, v65
  v_lshlrev_b32 v66, 16, v53
  v_and_b32 v67, s28, v53
  v_add_f32 v74, v74, v66
  v_add_f32 v75, v75, v67
  v_lshlrev_b32 v64, 16, v54
  v_and_b32 v65, s28, v54
  v_add_f32 v76, v76, v64
  v_add_f32 v77, v77, v65
  v_lshlrev_b32 v66, 16, v55
  v_and_b32 v67, s28, v55
  v_add_f32 v78, v78, v66
  v_add_f32 v79, v79, v67
  s_waitcnt lgkmcnt(1)
  v_lshlrev_b32 v64, 16, v56
  v_and_b32 v65, s28, v56
  v_add_f32 v72, v72, v64
  v_add_f32 v73, v73, v65
  v_lshlrev_b32 v66, 16, v57
  v_and_b32 v67, s28, v57
  v_add_f32 v74, v74, v66
  v_add_f32 v75, v75, v67
  v_lshlrev_b32 v64, 16, v58
  v_and_b32 v65, s28, v58
  v_add_f32 v76, v76, v64
  v_add_f32 v77, v77, v65
  v_lshlrev_b32 v66, 16, v59
  v_and_b32 v67, s28, v59
  v_add_f32 v78, v78, v66
  v_add_f32 v79, v79, v67
  s_waitcnt lgkmcnt(0)
  v_lshlrev_b32 v64, 16, v60
  v_and_b32 v65, s28, v60
  v_add_f32 v72, v72, v64
  v_add_f32 v73, v73, v65
  v_lshlrev_b32 v66, 16, v61
  v_and_b32 v67, s28, v61
  v_add_f32 v74, v74, v66
  v_add_f32 v75, v75, v67
  v_lshlrev_b32 v64, 16, v62
  v_and_b32 v65, s28, v62
  v_add_f32 v76, v76, v64
  v_add_f32 v77, v77, v65
  v_lshlrev_b32 v66, 16, v63
  v_and_b32 v67, s28, v63
  v_add_f32 v78, v78, v66
  v_add_f32 v79, v79, v67
  s_waitcnt vmcnt(0)
  v_lshlrev_b32 v124, 16, v104
  s_nop 0
  v_readlane_b32 s51, v124, 0
  v_readlane_b32 s52, v124, 32
  s_nop 1
  v_mov_b32 v138, s52
  v_mov_b32 v139, s51
  v_cmp_gt_u32 vcc, 32, v1
  s_nop 1
  v_cndmask_b32 v138, v138, v139, vcc
  v_lshlrev_b32 v132, 16, v104
  v_and_b32 v133, s28, v104
  v_lshlrev_b32 v134, 16, v114
  v_and_b32 v135, s28, v114
  v_sub_f32 v136, v132, v138
  v_sub_f32 v137, v133, v138
  v_mul_f32 v128, v132, v134
  v_add_f32 v124, v136, v137
  v_mul_f32 v126, v136, v136
  v_add_f32 v130, v134, v135
  v_fmac_f32 v128, v133, v135
  v_fmac_f32 v126, v137, v137
  v_lshlrev_b32 v132, 16, v105
  v_and_b32 v133, s28, v105
  v_lshlrev_b32 v134, 16, v115
  v_and_b32 v135, s28, v115
  v_sub_f32 v136, v132, v138
  v_sub_f32 v137, v133, v138
  v_fmac_f32 v128, v132, v134
  v_add_f32 v124, v124, v136
  v_fmac_f32 v126, v136, v136
  v_add_f32 v130, v130, v134
  v_fmac_f32 v128, v133, v135
  v_add_f32 v124, v124, v137
  v_fmac_f32 v126, v137, v137
  v_add_f32 v130, v130, v135
  v_lshlrev_b32 v132, 16, v106
  v_and_b32 v133, s28, v106
  v_lshlrev_b32 v134, 16, v116
  v_and_b32 v135, s28, v116
  v_sub_f32 v136, v132, v138
  v_sub_f32 v137, v133, v138
  v_fmac_f32 v128, v132, v134
  v_add_f32 v124, v124, v136
  v_fmac_f32 v126, v136, v136
  v_add_f32 v130, v130, v134
  v_fmac_f32 v128, v133, v135
  v_add_f32 v124, v124, v137
  v_fmac_f32 v126, v137, v137
  v_add_f32 v130, v130, v135
  v_lshlrev_b32 v132, 16, v107
  v_and_b32 v133, s28, v107
  v_lshlrev_b32 v134, 16, v117
  v_and_b32 v135, s28, v117
  v_sub_f32 v136, v132, v138
  v_sub_f32 v137, v133, v138
  v_fmac_f32 v128, v132, v134
  v_add_f32 v124, v124, v136
  v_fmac_f32 v126, v136, v136
  v_add_f32 v130, v130, v134
  v_fmac_f32 v128, v133, v135
  v_add_f32 v124, v124, v137
  v_fmac_f32 v126, v137, v137
  v_add_f32 v130, v130, v135
  v_lshlrev_b32 v132, 16, v108
  v_and_b32 v133, s28, v108
  v_lshlrev_b32 v134, 16, v118
  v_and_b32 v135, s28, v118
  v_sub_f32 v136, v132, v138
  v_sub_f32 v137, v133, v138
  v_fmac_f32 v128, v132, v134
  v_add_f32 v124, v124, v136
  v_fmac_f32 v126, v136, v136
  v_add_f32 v130, v130, v134
  v_fmac_f32 v128, v133, v135
  v_add_f32 v124, v124, v137
  v_fmac_f32 v126, v137, v137
  v_add_f32 v130, v130, v135
  v_lshlrev_b32 v132, 16, v109
  v_and_b32 v133, s28, v109
  v_lshlrev_b32 v134, 16, v119
  v_and_b32 v135, s28, v119
  v_sub_f32 v136, v132, v138
  v_sub_f32 v137, v133, v138
  v_fmac_f32 v128, v132, v134
  v_add_f32 v124, v124, v136
  v_fmac_f32 v126, v136, v136
  v_add_f32 v130, v130, v134
  v_fmac_f32 v128, v133, v135
  v_add_f32 v124, v124, v137
  v_fmac_f32 v126, v137, v137
  v_add_f32 v130, v130, v135
  v_lshlrev_b32 v132, 16, v110
  v_and_b32 v133, s28, v110
  v_lshlrev_b32 v134, 16, v120
  v_and_b32 v135, s28, v120
  v_sub_f32 v136, v132, v138
  v_sub_f32 v137, v133, v138
  v_fmac_f32 v128, v132, v134
  v_add_f32 v124, v124, v136
  v_fmac_f32 v126, v136, v136
  v_add_f32 v130, v130, v134
  v_fmac_f32 v128, v133, v135
  v_add_f32 v124, v124, v137
  v_fmac_f32 v126, v137, v137
  v_add_f32 v130, v130, v135
  v_lshlrev_b32 v132, 16, v111
  v_and_b32 v133, s28, v111
  v_lshlrev_b32 v134, 16, v121
  v_and_b32 v135, s28, v121
  v_sub_f32 v136, v132, v138
  v_sub_f32 v137, v133, v138
  v_fmac_f32 v128, v132, v134
  v_add_f32 v124, v124, v136
  v_fmac_f32 v126, v136, v136
  v_add_f32 v130, v130, v134
  v_fmac_f32 v128, v133, v135
  v_add_f32 v124, v124, v137
  v_fmac_f32 v126, v137, v137
  v_add_f32 v130, v130, v135
  v_lshlrev_b32 v132, 16, v112
  v_and_b32 v133, s28, v112
  v_lshlrev_b32 v134, 16, v122
  v_and_b32 v135, s28, v122
  v_sub_f32 v136, v132, v138
  v_sub_f32 v137, v133, v138
  v_fmac_f32 v128, v132, v134
  v_add_f32 v124, v124, v136
  v_fmac_f32 v126, v136, v136
  v_add_f32 v130, v130, v134
  v_fmac_f32 v128, v133, v135
  v_add_f32 v124, v124, v137
  v_fmac_f32 v126, v137, v137
  v_add_f32 v130, v130, v135
  v_lshlrev_b32 v132, 16, v113
  v_and_b32 v133, s28, v113
  v_lshlrev_b32 v134, 16, v123
  v_and_b32 v135, s28, v123
  v_sub_f32 v136, v132, v138
  v_sub_f32 v137, v133, v138
  v_fmac_f32 v128, v132, v134
  v_add_f32 v124, v124, v136
  v_fmac_f32 v126, v136, v136
  v_add_f32 v130, v130, v134
  v_fmac_f32 v128, v133, v135
  v_add_f32 v124, v124, v137
  v_fmac_f32 v126, v137, v137
  v_add_f32 v130, v130, v135
  v_add_f32_dpp v124, v124, v124 quad_perm:[1,0,3,2] row_mask:0xf bank_mask:0xf
  v_add_f32_dpp v126, v126, v126 quad_perm:[1,0,3,2] row_mask:0xf bank_mask:0xf
  v_add_f32_dpp v128, v128, v128 quad_perm:[1,0,3,2] row_mask:0xf bank_mask:0xf
  v_add_f32_dpp v130, v130, v130 quad_perm:[1,0,3,2] row_mask:0xf bank_mask:0xf
  v_add_f32_dpp v124, v124, v124 quad_perm:[2,3,0,1] row_mask:0xf bank_mask:0xf
  s_barrier
  ds_read_b128 v[48:51], v16 offset:32768
  ds_read_b128 v[52:55], v16 offset:33792
  ds_read_b128 v[56:59], v16 offset:34816
  ds_read_b128 v[60:63], v16 offset:35840
  s_waitcnt lgkmcnt(3)
  v_lshlrev_b32 v64, 16, v48
  v_and_b32 v65, s28, v48
  v_add_f32 v72, v72, v64
  v_add_f32 v73, v73, v65
  v_lshlrev_b32 v66, 16, v49
  v_and_b32 v67, s28, v49
  v_add_f32 v74, v74, v66
  v_add_f32 v75, v75, v67
  v_lshlrev_b32 v64, 16, v50
  v_and_b32 v65, s28, v50
  v_add_f32 v76, v76, v64
  v_add_f32 v77, v77, v65
  v_lshlrev_b32 v66, 16, v51
  v_and_b32 v67, s28, v51
  v_add_f32 v78, v78, v66
  v_add_f32 v79, v79, v67
  s_waitcnt lgkmcnt(2)
  v_lshlrev_b32 v64, 16, v52
  v_and_b32 v65, s28, v52
  v_add_f32 v72, v72, v64
  v_add_f32 v73, v73, v65
  v_lshlrev_b32 v66, 16, v53
  v_and_b32 v67, s28, v53
  v_add_f32 v74, v74, v66
  v_add_f32 v75, v75, v67
  v_lshlrev_b32 v64, 16, v54
  v_and_b32 v65, s28, v54
  v_add_f32 v76, v76, v64
  v_add_f32 v77, v77, v65
  v_lshlrev_b32 v66, 16, v55
  v_and_b32 v67, s28, v55
  v_add_f32 v78, v78, v66
  v_add_f32 v79, v79, v67
  s_waitcnt lgkmcnt(1)
  v_lshlrev_b32 v64, 16, v56
  v_and_b32 v65, s28, v56
  v_add_f32 v72, v72, v64
  v_add_f32 v73, v73, v65
  v_lshlrev_b32 v66, 16, v57
  v_and_b32 v67, s28, v57
  v_add_f32 v74, v74, v66
  v_add_f32 v75, v75, v67
  v_lshlrev_b32 v64, 16, v58
  v_and_b32 v65, s28, v58
  v_add_f32 v76, v76, v64
  v_add_f32 v77, v77, v65
  v_lshlrev_b32 v66, 16, v59
  v_and_b32 v67, s28, v59
  v_add_f32 v78, v78, v66
  v_add_f32 v79, v79, v67
  s_waitcnt lgkmcnt(0)
  v_lshlrev_b32 v64, 16, v60
  v_and_b32 v65, s28, v60
  v_add_f32 v72, v72, v64
  v_add_f32 v73, v73, v65
  v_lshlrev_b32 v66, 16, v61
  v_and_b32 v67, s28, v61
  v_add_f32 v74, v74, v66
  v_add_f32 v75, v75, v67
  v_lshlrev_b32 v64, 16, v62
  v_and_b32 v65, s28, v62
  v_add_f32 v76, v76, v64
  v_add_f32 v77, v77, v65
  v_lshlrev_b32 v66, 16, v63
  v_and_b32 v67, s28, v63
  v_add_f32 v78, v78, v66
  v_add_f32 v79, v79, v67
  v_add_f32_dpp v126, v126, v126 quad_perm:[2,3,0,1] row_mask:0xf bank_mask:0xf
  v_add_f32_dpp v128, v128, v128 quad_perm:[2,3,0,1] row_mask:0xf bank_mask:0xf
  v_add_f32_dpp v130, v130, v130 quad_perm:[2,3,0,1] row_mask:0xf bank_mask:0xf
  v_add_f32_dpp v124, v124, v124 row_half_mirror row_mask:0xf bank_mask:0xf
  v_add_f32_dpp v126, v126, v126 row_half_mirror row_mask:0xf bank_mask:0xf
  v_add_f32_dpp v128, v128, v128 row_half_mirror row_mask:0xf bank_mask:0xf
  v_add_f32_dpp v130, v130, v130 row_half_mirror row_mask:0xf bank_mask:0xf
  v_add_f32_dpp v124, v124, v124 row_mirror row_mask:0xf bank_mask:0xf
  v_add_f32_dpp v126, v126, v126 row_mirror row_mask:0xf bank_mask:0xf
  v_add_f32_dpp v128, v128, v128 row_mirror row_mask:0xf bank_mask:0xf
  v_add_f32_dpp v130, v130, v130 row_mirror row_mask:0xf bank_mask:0xf
  v_mov_b32 v125, v124
  v_mov_b32 v127, v126
  v_mov_b32 v129, v128
  v_mov_b32 v131, v130
  v_permlane16_swap_b32 v124, v125
  v_permlane16_swap_b32 v126, v127
  v_permlane16_swap_b32 v128, v129
  v_permlane16_swap_b32 v130, v131
  v_add_f32 v124, v124, v125
  v_add_f32 v126, v126, v127
  v_add_f32 v128, v128, v129
  v_add_f32 v130, v130, v131
  v_mul_f32 v124, s44, v124
  v_mul_f32 v132, v124, v124
  v_fma_f32 v126, v126, s44, -v132
  v_max_f32 v126, 0, v126
  v_add_f32 v124, v138, v124
  v_cvt_pk_bf16_f32 v124, v124, v124
  v_lshlrev_b32 v124, 16, v124
  v_cvt_pk_bf16_f32 v126, v126, v126
  v_lshlrev_b32 v126, 16, v126
  v_add_f32 v126, s45, v126
  v_cvt_pk_bf16_f32 v126, v126, v126
  v_lshlrev_b32 v126, 16, v126
  v_sqrt_f32 v126, v126
  s_nop 0
  v_cvt_pk_bf16_f32 v126, v126, v126
  v_lshlrev_b32 v126, 16, v126
  v_rcp_f32 v132, v126
  v_fma_f32 v128, -v124, v130, v128
  v_mul_f32 v128, v128, v132
  v_cvt_pk_bf16_f32 v141, v128, v128
  v_and_b32 v141, 0xffff, v141
  v_or_b32 v134, 0x8000, v141
  v_xor_b32 v135, 0xffff, v141
  v_cmp_lt_u32 vcc, 0x7fff, v141
  s_nop 1
  v_cndmask_b32 v141, v134, v135, vcc
  v_mov_b32 v134, 0
  v_cmp_u_f32 vcc, v128, v128
  s_nop 1
  v_cndmask_b32 v141, v141, v134, vcc
  v_sub_u32 v134, 0xfff, v20
  v_lshl_or_b32 v141, v141, 16, v134
  v_lshrrev_b32 v140, 16, v124
  v_or_b32 v140, v140, v126
  s_mov_b32 exec_lo, 1
  s_mov_b32 exec_hi, 1
  ds_write_b64 v21, v[140:141]
  s_mov_b64 exec, -1
  s_waitcnt lgkmcnt(0)
  s_barrier
  ds_read_b128 v[48:51], v16 offset:49152
  ds_read_b128 v[52:55], v16 offset:50176
  ds_read_b128 v[56:59], v16 offset:51200
  ds_read_b128 v[60:63], v16 offset:52224
  s_waitcnt lgkmcnt(3)
  v_lshlrev_b32 v64, 16, v48
  v_and_b32 v65, s28, v48
  v_add_f32 v72, v72, v64
  v_add_f32 v73, v73, v65
  v_lshlrev_b32 v66, 16, v49
  v_and_b32 v67, s28, v49
  v_add_f32 v74, v74, v66
  v_add_f32 v75, v75, v67
  v_lshlrev_b32 v64, 16, v50
  v_and_b32 v65, s28, v50
  v_add_f32 v76, v76, v64
  v_add_f32 v77, v77, v65
  v_lshlrev_b32 v66, 16, v51
  v_and_b32 v67, s28, v51
  v_add_f32 v78, v78, v66
  v_add_f32 v79, v79, v67
  s_waitcnt lgkmcnt(2)
  v_lshlrev_b32 v64, 16, v52
  v_and_b32 v65, s28, v52
  v_add_f32 v72, v72, v64
  v_add_f32 v73, v73, v65
  v_lshlrev_b32 v66, 16, v53
  v_and_b32 v67, s28, v53
  v_add_f32 v74, v74, v66
  v_add_f32 v75, v75, v67
  v_lshlrev_b32 v64, 16, v54
  v_and_b32 v65, s28, v54
  v_add_f32 v76, v76, v64
  v_add_f32 v77, v77, v65
  v_lshlrev_b32 v66, 16, v55
  v_and_b32 v67, s28, v55
  v_add_f32 v78, v78, v66
  v_add_f32 v79, v79, v67
  s_waitcnt lgkmcnt(1)
  v_lshlrev_b32 v64, 16, v56
  v_and_b32 v65, s28, v56
  v_add_f32 v72, v72, v64
  v_add_f32 v73, v73, v65
  v_lshlrev_b32 v66, 16, v57
  v_and_b32 v67, s28, v57
  v_add_f32 v74, v74, v66
  v_add_f32 v75, v75, v67
  v_lshlrev_b32 v64, 16, v58
  v_and_b32 v65, s28, v58
  v_add_f32 v76, v76, v64
  v_add_f32 v77, v77, v65
  v_lshlrev_b32 v66, 16, v59
  v_and_b32 v67, s28, v59
  v_add_f32 v78, v78, v66
  v_add_f32 v79, v79, v67
  s_waitcnt lgkmcnt(0)
  v_lshlrev_b32 v64, 16, v60
  v_and_b32 v65, s28, v60
  v_add_f32 v72, v72, v64
  v_add_f32 v73, v73, v65
  v_lshlrev_b32 v66, 16, v61
  v_and_b32 v67, s28, v61
  v_add_f32 v74, v74, v66
  v_add_f32 v75, v75, v67
  v_lshlrev_b32 v64, 16, v62
  v_and_b32 v65, s28, v62
  v_add_f32 v76, v76, v64
  v_add_f32 v77, v77, v65
  v_lshlrev_b32 v66, 16, v63
  v_and_b32 v67, s28, v63
  v_add_f32 v78, v78, v66
  v_add_f32 v79, v79, v67
  s_barrier
  ds_read_b128 v[48:51], v16 offset:0
  ds_read_b128 v[52:55], v16 offset:1024
  ds_read_b128 v[56:59], v16 offset:2048
  ds_read_b128 v[60:63], v16 offset:3072
  s_waitcnt lgkmcnt(3)
  v_lshlrev_b32 v64, 16, v48
  v_and_b32 v65, s28, v48
  v_add_f32 v72, v72, v64
  v_add_f32 v73, v73, v65
  v_lshlrev_b32 v66, 16, v49
  v_and_b32 v67, s28, v49
  v_add_f32 v74, v74, v66
  v_add_f32 v75, v75, v67
  v_lshlrev_b32 v64, 16, v50
  v_and_b32 v65, s28, v50
  v_add_f32 v76, v76, v64
  v_add_f32 v77, v77, v65
  v_lshlrev_b32 v66, 16, v51
  v_and_b32 v67, s28, v51
  v_add_f32 v78, v78, v66
  v_add_f32 v79, v79, v67
  s_waitcnt lgkmcnt(2)
  v_lshlrev_b32 v64, 16, v52
  v_and_b32 v65, s28, v52
  v_add_f32 v72, v72, v64
  v_add_f32 v73, v73, v65
  v_lshlrev_b32 v66, 16, v53
  v_and_b32 v67, s28, v53
  v_add_f32 v74, v74, v66
  v_add_f32 v75, v75, v67
  v_lshlrev_b32 v64, 16, v54
  v_and_b32 v65, s28, v54
  v_add_f32 v76, v76, v64
  v_add_f32 v77, v77, v65
  v_lshlrev_b32 v66, 16, v55
  v_and_b32 v67, s28, v55
  v_add_f32 v78, v78, v66
  v_add_f32 v79, v79, v67
  s_waitcnt lgkmcnt(1)
  v_lshlrev_b32 v64, 16, v56
  v_and_b32 v65, s28, v56
  v_add_f32 v72, v72, v64
  v_add_f32 v73, v73, v65
  v_lshlrev_b32 v66, 16, v57
  v_and_b32 v67, s28, v57
  v_add_f32 v74, v74, v66
  v_add_f32 v75, v75, v67
  v_lshlrev_b32 v64, 16, v58
  v_and_b32 v65, s28, v58
  v_add_f32 v76, v76, v64
  v_add_f32 v77, v77, v65
  v_lshlrev_b32 v66, 16, v59
  v_and_b32 v67, s28, v59
  v_add_f32 v78, v78, v66
  v_add_f32 v79, v79, v67
  s_waitcnt lgkmcnt(0)
  v_lshlrev_b32 v64, 16, v60
  v_and_b32 v65, s28, v60
  v_add_f32 v72, v72, v64
  v_add_f32 v73, v73, v65
  v_lshlrev_b32 v66, 16, v61
  v_and_b32 v67, s28, v61
  v_add_f32 v74, v74, v66
  v_add_f32 v75, v75, v67
  v_lshlrev_b32 v64, 16, v62
  v_and_b32 v65, s28, v62
  v_add_f32 v76, v76, v64
  v_add_f32 v77, v77, v65
  v_lshlrev_b32 v66, 16, v63
  v_and_b32 v67, s28, v63
  v_add_f32 v78, v78, v66
  v_add_f32 v79, v79, v67
  s_barrier
  ds_read_b128 v[48:51], v16 offset:16384
  ds_read_b128 v[52:55], v16 offset:17408
  ds_read_b128 v[56:59], v16 offset:18432
  ds_read_b128 v[60:63], v16 offset:19456
  s_waitcnt lgkmcnt(3)
  v_lshlrev_b32 v64, 16, v48
  v_and_b32 v65, s28, v48
  v_add_f32 v72, v72, v64
  v_add_f32 v73, v73, v65
  v_lshlrev_b32 v66, 16, v49
  v_and_b32 v67, s28, v49
  v_add_f32 v74, v74, v66
  v_add_f32 v75, v75, v67
  v_lshlrev_b32 v64, 16, v50
  v_and_b32 v65, s28, v50
  v_add_f32 v76, v76, v64
  v_add_f32 v77, v77, v65
  v_lshlrev_b32 v66, 16, v51
  v_and_b32 v67, s28, v51
  v_add_f32 v78, v78, v66
  v_add_f32 v79, v79, v67
  s_waitcnt lgkmcnt(2)
  v_lshlrev_b32 v64, 16, v52
  v_and_b32 v65, s28, v52
  v_add_f32 v72, v72, v64
  v_add_f32 v73, v73, v65
  v_lshlrev_b32 v66, 16, v53
  v_and_b32 v67, s28, v53
  v_add_f32 v74, v74, v66
  v_add_f32 v75, v75, v67
  v_lshlrev_b32 v64, 16, v54
  v_and_b32 v65, s28, v54
  v_add_f32 v76, v76, v64
  v_add_f32 v77, v77, v65
  v_lshlrev_b32 v66, 16, v55
  v_and_b32 v67, s28, v55
  v_add_f32 v78, v78, v66
  v_add_f32 v79, v79, v67
  s_waitcnt lgkmcnt(1)
  v_lshlrev_b32 v64, 16, v56
  v_and_b32 v65, s28, v56
  v_add_f32 v72, v72, v64
  v_add_f32 v73, v73, v65
  v_lshlrev_b32 v66, 16, v57
  v_and_b32 v67, s28, v57
  v_add_f32 v74, v74, v66
  v_add_f32 v75, v75, v67
  v_lshlrev_b32 v64, 16, v58
  v_and_b32 v65, s28, v58
  v_add_f32 v76, v76, v64
  v_add_f32 v77, v77, v65
  v_lshlrev_b32 v66, 16, v59
  v_and_b32 v67, s28, v59
  v_add_f32 v78, v78, v66
  v_add_f32 v79, v79, v67
  s_waitcnt lgkmcnt(0)
  v_lshlrev_b32 v64, 16, v60
  v_and_b32 v65, s28, v60
  v_add_f32 v72, v72, v64
  v_add_f32 v73, v73, v65
  v_lshlrev_b32 v66, 16, v61
  v_and_b32 v67, s28, v61
  v_add_f32 v74, v74, v66
  v_add_f32 v75, v75, v67
  v_lshlrev_b32 v64, 16, v62
  v_and_b32 v65, s28, v62
  v_add_f32 v76, v76, v64
  v_add_f32 v77, v77, v65
  v_lshlrev_b32 v66, 16, v63
  v_and_b32 v67, s28, v63
  v_add_f32 v78, v78, v66
  v_add_f32 v79, v79, v67
  s_barrier
  ds_read_b128 v[48:51], v16 offset:32768
  ds_read_b128 v[52:55], v16 offset:33792
  ds_read_b128 v[56:59], v16 offset:34816
  ds_read_b128 v[60:63], v16 offset:35840
  s_waitcnt lgkmcnt(3)
  v_lshlrev_b32 v64, 16, v48
  v_and_b32 v65, s28, v48
  v_add_f32 v72, v72, v64
  v_add_f32 v73, v73, v65
  v_lshlrev_b32 v66, 16, v49
  v_and_b32 v67, s28, v49
  v_add_f32 v74, v74, v66
  v_add_f32 v75, v75, v67
  v_lshlrev_b32 v64, 16, v50
  v_and_b32 v65, s28, v50
  v_add_f32 v76, v76, v64
  v_add_f32 v77, v77, v65
  v_lshlrev_b32 v66, 16, v51
  v_and_b32 v67, s28, v51
  v_add_f32 v78, v78, v66
  v_add_f32 v79, v79, v67
  s_waitcnt lgkmcnt(2)
  v_lshlrev_b32 v64, 16, v52
  v_and_b32 v65, s28, v52
  v_add_f32 v72, v72, v64
  v_add_f32 v73, v73, v65
  v_lshlrev_b32 v66, 16, v53
  v_and_b32 v67, s28, v53
  v_add_f32 v74, v74, v66
  v_add_f32 v75, v75, v67
  v_lshlrev_b32 v64, 16, v54
  v_and_b32 v65, s28, v54
  v_add_f32 v76, v76, v64
  v_add_f32 v77, v77, v65
  v_lshlrev_b32 v66, 16, v55
  v_and_b32 v67, s28, v55
  v_add_f32 v78, v78, v66
  v_add_f32 v79, v79, v67
  s_waitcnt lgkmcnt(1)
  v_lshlrev_b32 v64, 16, v56
  v_and_b32 v65, s28, v56
  v_add_f32 v72, v72, v64
  v_add_f32 v73, v73, v65
  v_lshlrev_b32 v66, 16, v57
  v_and_b32 v67, s28, v57
  v_add_f32 v74, v74, v66
  v_add_f32 v75, v75, v67
  v_lshlrev_b32 v64, 16, v58
  v_and_b32 v65, s28, v58
  v_add_f32 v76, v76, v64
  v_add_f32 v77, v77, v65
  v_lshlrev_b32 v66, 16, v59
  v_and_b32 v67, s28, v59
  v_add_f32 v78, v78, v66
  v_add_f32 v79, v79, v67
  s_waitcnt lgkmcnt(0)
  v_lshlrev_b32 v64, 16, v60
  v_and_b32 v65, s28, v60
  v_add_f32 v72, v72, v64
  v_add_f32 v73, v73, v65
  v_lshlrev_b32 v66, 16, v61
  v_and_b32 v67, s28, v61
  v_add_f32 v74, v74, v66
  v_add_f32 v75, v75, v67
  v_lshlrev_b32 v64, 16, v62
  v_and_b32 v65, s28, v62
  v_add_f32 v76, v76, v64
  v_add_f32 v77, v77, v65
  v_lshlrev_b32 v66, 16, v63
  v_and_b32 v67, s28, v63
  v_add_f32 v78, v78, v66
  v_add_f32 v79, v79, v67
  s_barrier
  ds_read_b128 v[48:51], v16 offset:49152
  ds_read_b128 v[52:55], v16 offset:50176
  ds_read_b128 v[56:59], v16 offset:51200
  ds_read_b128 v[60:63], v16 offset:52224
  s_waitcnt lgkmcnt(3)
  v_lshlrev_b32 v64, 16, v48
  v_and_b32 v65, s28, v48
  v_add_f32 v72, v72, v64
  v_add_f32 v73, v73, v65
  v_lshlrev_b32 v66, 16, v49
  v_and_b32 v67, s28, v49
  v_add_f32 v74, v74, v66
  v_add_f32 v75, v75, v67
  v_lshlrev_b32 v64, 16, v50
  v_and_b32 v65, s28, v50
  v_add_f32 v76, v76, v64
  v_add_f32 v77, v77, v65
  v_lshlrev_b32 v66, 16, v51
  v_and_b32 v67, s28, v51
  v_add_f32 v78, v78, v66
  v_add_f32 v79, v79, v67
  s_waitcnt lgkmcnt(2)
  v_lshlrev_b32 v64, 16, v52
  v_and_b32 v65, s28, v52
  v_add_f32 v72, v72, v64
  v_add_f32 v73, v73, v65
  v_lshlrev_b32 v66, 16, v53
  v_and_b32 v67, s28, v53
  v_add_f32 v74, v74, v66
  v_add_f32 v75, v75, v67
  v_lshlrev_b32 v64, 16, v54
  v_and_b32 v65, s28, v54
  v_add_f32 v76, v76, v64
  v_add_f32 v77, v77, v65
  v_lshlrev_b32 v66, 16, v55
  v_and_b32 v67, s28, v55
  v_add_f32 v78, v78, v66
  v_add_f32 v79, v79, v67
  s_waitcnt lgkmcnt(1)
  v_lshlrev_b32 v64, 16, v56
  v_and_b32 v65, s28, v56
  v_add_f32 v72, v72, v64
  v_add_f32 v73, v73, v65
  v_lshlrev_b32 v66, 16, v57
  v_and_b32 v67, s28, v57
  v_add_f32 v74, v74, v66
  v_add_f32 v75, v75, v67
  v_lshlrev_b32 v64, 16, v58
  v_and_b32 v65, s28, v58
  v_add_f32 v76, v76, v64
  v_add_f32 v77, v77, v65
  v_lshlrev_b32 v66, 16, v59
  v_and_b32 v67, s28, v59
  v_add_f32 v78, v78, v66
  v_add_f32 v79, v79, v67
  s_waitcnt lgkmcnt(0)
  v_lshlrev_b32 v64, 16, v60
  v_and_b32 v65, s28, v60
  v_add_f32 v72, v72, v64
  v_add_f32 v73, v73, v65
  v_lshlrev_b32 v66, 16, v61
  v_and_b32 v67, s28, v61
  v_add_f32 v74, v74, v66
  v_add_f32 v75, v75, v67
  v_lshlrev_b32 v64, 16, v62
  v_and_b32 v65, s28, v62
  v_add_f32 v76, v76, v64
  v_add_f32 v77, v77, v65
  v_lshlrev_b32 v66, 16, v63
  v_and_b32 v67, s28, v63
  v_add_f32 v78, v78, v66
  v_add_f32 v79, v79, v67
  s_barrier
  ds_read_b128 v[48:51], v16 offset:0
  ds_read_b128 v[52:55], v16 offset:1024
  ds_read_b128 v[56:59], v16 offset:2048
  ds_read_b128 v[60:63], v16 offset:3072
  s_waitcnt lgkmcnt(3)
  v_lshlrev_b32 v64, 16, v48
  v_and_b32 v65, s28, v48
  v_add_f32 v72, v72, v64
  v_add_f32 v73, v73, v65
  v_lshlrev_b32 v66, 16, v49
  v_and_b32 v67, s28, v49
  v_add_f32 v74, v74, v66
  v_add_f32 v75, v75, v67
  v_lshlrev_b32 v64, 16, v50
  v_and_b32 v65, s28, v50
  v_add_f32 v76, v76, v64
  v_add_f32 v77, v77, v65
  v_lshlrev_b32 v66, 16, v51
  v_and_b32 v67, s28, v51
  v_add_f32 v78, v78, v66
  v_add_f32 v79, v79, v67
  s_waitcnt lgkmcnt(2)
  v_lshlrev_b32 v64, 16, v52
  v_and_b32 v65, s28, v52
  v_add_f32 v72, v72, v64
  v_add_f32 v73, v73, v65
  v_lshlrev_b32 v66, 16, v53
  v_and_b32 v67, s28, v53
  v_add_f32 v74, v74, v66
  v_add_f32 v75, v75, v67
  v_lshlrev_b32 v64, 16, v54
  v_and_b32 v65, s28, v54
  v_add_f32 v76, v76, v64
  v_add_f32 v77, v77, v65
  v_lshlrev_b32 v66, 16, v55
  v_and_b32 v67, s28, v55
  v_add_f32 v78, v78, v66
  v_add_f32 v79, v79, v67
  s_waitcnt lgkmcnt(1)
  v_lshlrev_b32 v64, 16, v56
  v_and_b32 v65, s28, v56
  v_add_f32 v72, v72, v64
  v_add_f32 v73, v73, v65
  v_lshlrev_b32 v66, 16, v57
  v_and_b32 v67, s28, v57
  v_add_f32 v74, v74, v66
  v_add_f32 v75, v75, v67
  v_lshlrev_b32 v64, 16, v58
  v_and_b32 v65, s28, v58
  v_add_f32 v76, v76, v64
  v_add_f32 v77, v77, v65
  v_lshlrev_b32 v66, 16, v59
  v_and_b32 v67, s28, v59
  v_add_f32 v78, v78, v66
  v_add_f32 v79, v79, v67
  s_waitcnt lgkmcnt(0)
  v_lshlrev_b32 v64, 16, v60
  v_and_b32 v65, s28, v60
  v_add_f32 v72, v72, v64
  v_add_f32 v73, v73, v65
  v_lshlrev_b32 v66, 16, v61
  v_and_b32 v67, s28, v61
  v_add_f32 v74, v74, v66
  v_add_f32 v75, v75, v67
  v_lshlrev_b32 v64, 16, v62
  v_and_b32 v65, s28, v62
  v_add_f32 v76, v76, v64
  v_add_f32 v77, v77, v65
  v_lshlrev_b32 v66, 16, v63
  v_and_b32 v67, s28, v63
  v_add_f32 v78, v78, v66
  v_add_f32 v79, v79, v67
  s_barrier
  ds_read_b128 v[48:51], v16 offset:16384
  ds_read_b128 v[52:55], v16 offset:17408
  ds_read_b128 v[56:59], v16 offset:18432
  ds_read_b128 v[60:63], v16 offset:19456
  s_waitcnt lgkmcnt(3)
  v_lshlrev_b32 v64, 16, v48
  v_and_b32 v65, s28, v48
  v_add_f32 v72, v72, v64
  v_add_f32 v73, v73, v65
  v_lshlrev_b32 v66, 16, v49
  v_and_b32 v67, s28, v49
  v_add_f32 v74, v74, v66
  v_add_f32 v75, v75, v67
  v_lshlrev_b32 v64, 16, v50
  v_and_b32 v65, s28, v50
  v_add_f32 v76, v76, v64
  v_add_f32 v77, v77, v65
  v_lshlrev_b32 v66, 16, v51
  v_and_b32 v67, s28, v51
  v_add_f32 v78, v78, v66
  v_add_f32 v79, v79, v67
  s_waitcnt lgkmcnt(2)
  v_lshlrev_b32 v64, 16, v52
  v_and_b32 v65, s28, v52
  v_add_f32 v72, v72, v64
  v_add_f32 v73, v73, v65
  v_lshlrev_b32 v66, 16, v53
  v_and_b32 v67, s28, v53
  v_add_f32 v74, v74, v66
  v_add_f32 v75, v75, v67
  v_lshlrev_b32 v64, 16, v54
  v_and_b32 v65, s28, v54
  v_add_f32 v76, v76, v64
  v_add_f32 v77, v77, v65
  v_lshlrev_b32 v66, 16, v55
  v_and_b32 v67, s28, v55
  v_add_f32 v78, v78, v66
  v_add_f32 v79, v79, v67
  s_waitcnt lgkmcnt(1)
  v_lshlrev_b32 v64, 16, v56
  v_and_b32 v65, s28, v56
  v_add_f32 v72, v72, v64
  v_add_f32 v73, v73, v65
  v_lshlrev_b32 v66, 16, v57
  v_and_b32 v67, s28, v57
  v_add_f32 v74, v74, v66
  v_add_f32 v75, v75, v67
  v_lshlrev_b32 v64, 16, v58
  v_and_b32 v65, s28, v58
  v_add_f32 v76, v76, v64
  v_add_f32 v77, v77, v65
  v_lshlrev_b32 v66, 16, v59
  v_and_b32 v67, s28, v59
  v_add_f32 v78, v78, v66
  v_add_f32 v79, v79, v67
  s_waitcnt lgkmcnt(0)
  v_lshlrev_b32 v64, 16, v60
  v_and_b32 v65, s28, v60
  v_add_f32 v72, v72, v64
  v_add_f32 v73, v73, v65
  v_lshlrev_b32 v66, 16, v61
  v_and_b32 v67, s28, v61
  v_add_f32 v74, v74, v66
  v_add_f32 v75, v75, v67
  v_lshlrev_b32 v64, 16, v62
  v_and_b32 v65, s28, v62
  v_add_f32 v76, v76, v64
  v_add_f32 v77, v77, v65
  v_lshlrev_b32 v66, 16, v63
  v_and_b32 v67, s28, v63
  v_add_f32 v78, v78, v66
  v_add_f32 v79, v79, v67
  v_permlane32_swap_b32 v72, v73
  v_permlane32_swap_b32 v74, v75
  v_permlane32_swap_b32 v76, v77
  v_permlane32_swap_b32 v78, v79
  v_add_f32 v72, v72, v73
  v_add_f32 v74, v74, v75
  v_add_f32 v76, v76, v77
  v_add_f32 v78, v78, v79
  v_permlane16_swap_b32 v72, v74
  s_nop 0
  v_permlane16_swap_b32 v76, v78
  v_add_f32 v72, v72, v74
  v_add_f32 v76, v76, v78
  v_and_b32 v7, 15, v1
  v_lshlrev_b32 v7, 3, v7
  v_bfe_u32 v8, v1, 4, 1
  v_lshl_add_u32 v7, v8, 1, v7
  v_add_u32 v7, v7, v3
  s_lshl_b32 s29, s21, 9
  s_add_u32 s29, s29, 133248
  v_lshl_add_u32 v7, v7, 2, s29
  ds_write_b32 v7, v72
  ds_write_b32 v7, v76 offset:16
  s_waitcnt lgkmcnt(0)
  s_branch L_a_bE1
L_end:
  s_endpgm
L_loader:
  s_setprio 2
  s_sub_u32 s21, s16, 8
  v_lshrrev_b32 v3, 4, v1
  s_load_dwordx2 s[52:53], s[0:1], 16
  s_lshl_b32 s29, s21, 4
  s_add_u32 s29, s29, 40
  s_load_dwordx2 s[56:57], s[0:1], s29
  s_load_dwordx2 s[92:93], s[0:1], 48
  s_mov_b32 s58, 1966080
  s_mov_b32 s59, 0x20000
  s_mov_b32 s94, 1966080
  s_mov_b32 s95, 0x20000
  s_cmp_eq_u32 s21, 1
  s_cbranch_scc1 L_l_w
  v_lshrrev_b32 v2, 3, v1
  v_and_b32 v8, 7, v1
  v_xor_b32 v8, v8, v3
  s_lshl_b32 s23, s19, 7
  v_add_u32 v9, s23, v2
  v_mul_u32_u24 v9, 1280, v9
  v_lshl_add_u32 v10, v8, 4, v9
  v_xor_b32 v8, 4, v8
  v_lshl_add_u32 v11, v8, 4, v9
  s_mov_b64 s[24:25], -1
  s_mov_b32 s26, 0
  s_movk_i32 s27, 10240
  s_movk_i32 s31, 128
  s_mov_b32 s32, 0
  s_branch L_l_go
L_l_w:
  v_and_b32 v8, 15, v1
  v_lshlrev_b32 v17, 2, v3
  v_xor_b32 v17, v8, v17
  s_lshl_b32 s29, s20, 2
  s_mul_i32 s31, s46, 40
  v_lshrrev_b32 v19, 2, v17
  v_add_u32 v19, s29, v19
  v_cmp_gt_u32 s[24:25], 30, v19
  v_mul_u32_u24 v18, 26, v19
  v_lshrrev_b32 v18, 8, v18
  v_mul_u32_u24 v18, 40, v18
  v_lshl_add_u32 v18, v19, 2, v18
  v_and_b32 v19, 3, v17
  v_add3_u32 v18, v18, v19, s31
  v_lshlrev_b32 v18, 4, v18
  v_mul_u32_u24 v19, 3840, v3
  v_add_u32 v10, v18, v19
  v_mov_b32 v11, v10
  s_mov_b32 s26, 65536
  s_movk_i32 s27, 15360
  s_mov_b32 s31, 245760
  s_mov_b32 s32, 0
L_l_go:
  s_waitcnt lgkmcnt(0)
  s_mov_b32 s54, 819200
  s_mov_b32 s55, 0x20000
  s_and_b32 s41, s20, 7
  s_mul_i32 s40, s41, 1
  s_and_b32 s41, s48, 3
  s_mul_i32 s41, s41, 3
  s_add_u32 s40, s40, s41
  s_mul_i32 s41, s46, 5
  s_add_u32 s40, s40, s41
  s_mul_i32 s41, s47, 0
  s_add_u32 s40, s40, s41
  s_mul_i32 s41, s40, 205
  s_lshr_b32 s41, s41, 11
  s_mul_i32 s41, s41, 10
  s_sub_u32 s40, s40, s41
  s_movk_i32 s42, 128
  s_cmp_eq_u32 s21, 0
  s_cselect_b32 s41, s42, 245760
  s_mul_i32 s40, s40, s41
  s_cmp_eq_u32 s21, 1
  s_cbranch_scc1 L_l_r1
  s_mov_b64 exec, s[24:25]
  s_mov_b32 m0, 0
  s_add_u32 s30, s40, 0
  buffer_load_dwordx4 v10, s[4:7], s30 offen lds
  s_mov_b32 m0, 1024
  s_add_u32 s30, s40, 10240
  buffer_load_dwordx4 v11, s[4:7], s30 offen lds
  s_mov_b32 m0, 2048
  s_add_u32 s30, s40, 20480
  buffer_load_dwordx4 v10, s[4:7], s30 offen lds
  s_mov_b32 m0, 3072
  s_add_u32 s30, s40, 30720
  buffer_load_dwordx4 v11, s[4:7], s30 offen lds
  s_mov_b32 m0, 4096
  s_add_u32 s30, s40, 40960
  buffer_load_dwordx4 v10, s[4:7], s30 offen lds
  s_mov_b32 m0, 5120
  s_add_u32 s30, s40, 51200
  buffer_load_dwordx4 v11, s[4:7], s30 offen lds
  s_mov_b32 m0, 6144
  s_add_u32 s30, s40, 61440
  buffer_load_dwordx4 v10, s[4:7], s30 offen lds
  s_mov_b32 m0, 7168
  s_add_u32 s30, s40, 71680
  buffer_load_dwordx4 v11, s[4:7], s30 offen lds
  s_mov_b32 m0, 8192
  s_add_u32 s30, s40, 81920
  buffer_load_dwordx4 v10, s[4:7], s30 offen lds
  s_mov_b32 m0, 9216
  s_add_u32 s30, s40, 92160
  buffer_load_dwordx4 v11, s[4:7], s30 offen lds
  s_mov_b32 m0, 10240
  s_add_u32 s30, s40, 102400
  buffer_load_dwordx4 v10, s[4:7], s30 offen lds
  s_mov_b32 m0, 11264
  s_add_u32 s30, s40, 112640
  buffer_load_dwordx4 v11, s[4:7], s30 offen lds
  s_mov_b32 m0, 12288
  s_add_u32 s30, s40, 122880
  buffer_load_dwordx4 v10, s[4:7], s30 offen lds
  s_mov_b32 m0, 13312
  s_add_u32 s30, s40, 133120
  buffer_load_dwordx4 v11, s[4:7], s30 offen lds
  s_mov_b32 m0, 14336
  s_add_u32 s30, s40, 143360
  buffer_load_dwordx4 v10, s[4:7], s30 offen lds
  s_mov_b32 m0, 15360
  s_add_u32 s30, s40, 153600
  buffer_load_dwordx4 v11, s[4:7], s30 offen lds
  s_add_u32 s40, s40, 128
  s_cmp_eq_u32 s40, 1280
  s_cselect_b32 s40, 0, s40
  s_mov_b32 m0, 16384
  s_add_u32 s30, s40, 0
  buffer_load_dwordx4 v10, s[4:7], s30 offen lds
  s_mov_b32 m0, 17408
  s_add_u32 s30, s40, 10240
  buffer_load_dwordx4 v11, s[4:7], s30 offen lds
  s_mov_b32 m0, 18432
  s_add_u32 s30, s40, 20480
  buffer_load_dwordx4 v10, s[4:7], s30 offen lds
  s_mov_b32 m0, 19456
  s_add_u32 s30, s40, 30720
  buffer_load_dwordx4 v11, s[4:7], s30 offen lds
  s_mov_b32 m0, 20480
  s_add_u32 s30, s40, 40960
  buffer_load_dwordx4 v10, s[4:7], s30 offen lds
  s_mov_b32 m0, 21504
  s_add_u32 s30, s40, 51200
  buffer_load_dwordx4 v11, s[4:7], s30 offen lds
  s_mov_b32 m0, 22528
  s_add_u32 s30, s40, 61440
  buffer_load_dwordx4 v10, s[4:7], s30 offen lds
  s_mov_b32 m0, 23552
  s_add_u32 s30, s40, 71680
  buffer_load_dwordx4 v11, s[4:7], s30 offen lds
  s_mov_b32 m0, 24576
  s_add_u32 s30, s40, 81920
  buffer_load_dwordx4 v10, s[4:7], s30 offen lds
  s_mov_b32 m0, 25600
  s_add_u32 s30, s40, 92160
  buffer_load_dwordx4 v11, s[4:7], s30 offen lds
  s_mov_b32 m0, 26624
  s_add_u32 s30, s40, 102400
  buffer_load_dwordx4 v10, s[4:7], s30 offen lds
  s_mov_b32 m0, 27648
  s_add_u32 s30, s40, 112640
  buffer_load_dwordx4 v11, s[4:7], s30 offen lds
  s_mov_b32 m0, 28672
  s_add_u32 s30, s40, 122880
  buffer_load_dwordx4 v10, s[4:7], s30 offen lds
  s_mov_b32 m0, 29696
  s_add_u32 s30, s40, 133120
  buffer_load_dwordx4 v11, s[4:7], s30 offen lds
  s_mov_b32 m0, 30720
  s_add_u32 s30, s40, 143360
  buffer_load_dwordx4 v10, s[4:7], s30 offen lds
  s_mov_b32 m0, 31744
  s_add_u32 s30, s40, 153600
  buffer_load_dwordx4 v11, s[4:7], s30 offen lds
  s_add_u32 s40, s40, 128
  s_cmp_eq_u32 s40, 1280
  s_cselect_b32 s40, 0, s40
  s_waitcnt vmcnt(16)
  s_barrier
  s_mov_b32 m0, 32768
  s_add_u32 s30, s40, 0
  buffer_load_dwordx4 v10, s[4:7], s30 offen lds
  s_mov_b32 m0, 33792
  s_add_u32 s30, s40, 10240
  buffer_load_dwordx4 v11, s[4:7], s30 offen lds
  s_mov_b32 m0, 34816
  s_add_u32 s30, s40, 20480
  buffer_load_dwordx4 v10, s[4:7], s30 offen lds
  s_mov_b32 m0, 35840
  s_add_u32 s30, s40, 30720
  buffer_load_dwordx4 v11, s[4:7], s30 offen lds
  s_mov_b32 m0, 36864
  s_add_u32 s30, s40, 40960
  buffer_load_dwordx4 v10, s[4:7], s30 offen lds
  s_mov_b32 m0, 37888
  s_add_u32 s30, s40, 51200
  buffer_load_dwordx4 v11, s[4:7], s30 offen lds
  s_mov_b32 m0, 38912
  s_add_u32 s30, s40, 61440
  buffer_load_dwordx4 v10, s[4:7], s30 offen lds
  s_mov_b32 m0, 39936
  s_add_u32 s30, s40, 71680
  buffer_load_dwordx4 v11, s[4:7], s30 offen lds
  s_mov_b32 m0, 40960
  s_add_u32 s30, s40, 81920
  buffer_load_dwordx4 v10, s[4:7], s30 offen lds
  s_mov_b32 m0, 41984
  s_add_u32 s30, s40, 92160
  buffer_load_dwordx4 v11, s[4:7], s30 offen lds
  s_mov_b32 m0, 43008
  s_add_u32 s30, s40, 102400
  buffer_load_dwordx4 v10, s[4:7], s30 offen lds
  s_mov_b32 m0, 44032
  s_add_u32 s30, s40, 112640
  buffer_load_dwordx4 v11, s[4:7], s30 offen lds
  s_mov_b32 m0, 45056
  s_add_u32 s30, s40, 122880
  buffer_load_dwordx4 v10, s[4:7], s30 offen lds
  s_mov_b32 m0, 46080
  s_add_u32 s30, s40, 133120
  buffer_load_dwordx4 v11, s[4:7], s30 offen lds
  s_mov_b32 m0, 47104
  s_add_u32 s30, s40, 143360
  buffer_load_dwordx4 v10, s[4:7], s30 offen lds
  s_mov_b32 m0, 48128
  s_add_u32 s30, s40, 153600
  buffer_load_dwordx4 v11, s[4:7], s30 offen lds
  s_add_u32 s40, s40, 128
  s_cmp_eq_u32 s40, 1280
  s_cselect_b32 s40, 0, s40
  s_waitcnt vmcnt(16)
  s_barrier
  s_mov_b32 m0, 49152
  s_add_u32 s30, s40, 0
  buffer_load_dwordx4 v10, s[4:7], s30 offen lds
  s_mov_b32 m0, 50176
  s_add_u32 s30, s40, 10240
  buffer_load_dwordx4 v11, s[4:7], s30 offen lds
  s_mov_b32 m0, 51200
  s_add_u32 s30, s40, 20480
  buffer_load_dwordx4 v10, s[4:7], s30 offen lds
  s_mov_b32 m0, 52224
  s_add_u32 s30, s40, 30720
  buffer_load_dwordx4 v11, s[4:7], s30 offen lds
  s_mov_b32 m0, 53248
  s_add_u32 s30, s40, 40960
  buffer_load_dwordx4 v10, s[4:7], s30 offen lds
  s_mov_b32 m0, 54272
  s_add_u32 s30, s40, 51200
  buffer_load_dwordx4 v11, s[4:7], s30 offen lds
  s_mov_b32 m0, 55296
  s_add_u32 s30, s40, 61440
  buffer_load_dwordx4 v10, s[4:7], s30 offen lds
  s_mov_b32 m0, 56320
  s_add_u32 s30, s40, 71680
  buffer_load_dwordx4 v11, s[4:7], s30 offen lds
  s_mov_b32 m0, 57344
  s_add_u32 s30, s40, 81920
  buffer_load_dwordx4 v10, s[4:7], s30 offen lds
  s_mov_b32 m0, 58368
  s_add_u32 s30, s40, 92160
  buffer_load_dwordx4 v11, s[4:7], s30 offen lds
  s_mov_b32 m0, 59392
  s_add_u32 s30, s40, 102400
  buffer_load_dwordx4 v10, s[4:7], s30 offen lds
  s_mov_b32 m0, 60416
  s_add_u32 s30, s40, 112640
  buffer_load_dwordx4 v11, s[4:7], s30 offen lds
  s_mov_b32 m0, 61440
  s_add_u32 s30, s40, 122880
  buffer_load_dwordx4 v10, s[4:7], s30 offen lds
  s_mov_b32 m0, 62464
  s_add_u32 s30, s40, 133120
  buffer_load_dwordx4 v11, s[4:7], s30 offen lds
  s_mov_b32 m0, 63488
  s_add_u32 s30, s40, 143360
  buffer_load_dwordx4 v10, s[4:7], s30 offen lds
  s_mov_b32 m0, 64512
  s_add_u32 s30, s40, 153600
  buffer_load_dwordx4 v11, s[4:7], s30 offen lds
  s_add_u32 s40, s40, 128
  s_cmp_eq_u32 s40, 1280
  s_cselect_b32 s40, 0, s40
  s_waitcnt vmcnt(16)
  s_barrier
  s_mov_b32 m0, 0
  s_add_u32 s30, s40, 0
  buffer_load_dwordx4 v10, s[4:7], s30 offen lds
  s_mov_b32 m0, 1024
  s_add_u32 s30, s40, 10240
  buffer_load_dwordx4 v11, s[4:7], s30 offen lds
  s_mov_b32 m0, 2048
  s_add_u32 s30, s40, 20480
  buffer_load_dwordx4 v10, s[4:7], s30 offen lds
  s_mov_b32 m0, 3072
  s_add_u32 s30, s40, 30720
  buffer_load_dwordx4 v11, s[4:7], s30 offen lds
  s_mov_b32 m0, 4096
  s_add_u32 s30, s40, 40960
  buffer_load_dwordx4 v10, s[4:7], s30 offen lds
  s_mov_b32 m0, 5120
  s_add_u32 s30, s40, 51200
  buffer_load_dwordx4 v11, s[4:7], s30 offen lds
  s_mov_b32 m0, 6144
  s_add_u32 s30, s40, 61440
  buffer_load_dwordx4 v10, s[4:7], s30 offen lds
  s_mov_b32 m0, 7168
  s_add_u32 s30, s40, 71680
  buffer_load_dwordx4 v11, s[4:7], s30 offen lds
  s_mov_b32 m0, 8192
  s_add_u32 s30, s40, 81920
  buffer_load_dwordx4 v10, s[4:7], s30 offen lds
  s_mov_b32 m0, 9216
  s_add_u32 s30, s40, 92160
  buffer_load_dwordx4 v11, s[4:7], s30 offen lds
  s_mov_b32 m0, 10240
  s_add_u32 s30, s40, 102400
  buffer_load_dwordx4 v10, s[4:7], s30 offen lds
  s_mov_b32 m0, 11264
  s_add_u32 s30, s40, 112640
  buffer_load_dwordx4 v11, s[4:7], s30 offen lds
  s_mov_b32 m0, 12288
  s_add_u32 s30, s40, 122880
  buffer_load_dwordx4 v10, s[4:7], s30 offen lds
  s_mov_b32 m0, 13312
  s_add_u32 s30, s40, 133120
  buffer_load_dwordx4 v11, s[4:7], s30 offen lds
  s_mov_b32 m0, 14336
  s_add_u32 s30, s40, 143360
  buffer_load_dwordx4 v10, s[4:7], s30 offen lds
  s_mov_b32 m0, 15360
  s_add_u32 s30, s40, 153600
  buffer_load_dwordx4 v11, s[4:7], s30 offen lds
  s_add_u32 s40, s40, 128
  s_cmp_eq_u32 s40, 1280
  s_cselect_b32 s40, 0, s40
  s_waitcnt vmcnt(16)
  s_barrier
  s_mov_b32 m0, 16384
  s_add_u32 s30, s40, 0
  buffer_load_dwordx4 v10, s[4:7], s30 offen lds
  s_mov_b32 m0, 17408
  s_add_u32 s30, s40, 10240
  buffer_load_dwordx4 v11, s[4:7], s30 offen lds
  s_mov_b32 m0, 18432
  s_add_u32 s30, s40, 20480
  buffer_load_dwordx4 v10, s[4:7], s30 offen lds
  s_mov_b32 m0, 19456
  s_add_u32 s30, s40, 30720
  buffer_load_dwordx4 v11, s[4:7], s30 offen lds
  s_mov_b32 m0, 20480
  s_add_u32 s30, s40, 40960
  buffer_load_dwordx4 v10, s[4:7], s30 offen lds
  s_mov_b32 m0, 21504
  s_add_u32 s30, s40, 51200
  buffer_load_dwordx4 v11, s[4:7], s30 offen lds
  s_mov_b32 m0, 22528
  s_add_u32 s30, s40, 61440
  buffer_load_dwordx4 v10, s[4:7], s30 offen lds
  s_mov_b32 m0, 23552
  s_add_u32 s30, s40, 71680
  buffer_load_dwordx4 v11, s[4:7], s30 offen lds
  s_mov_b32 m0, 24576
  s_add_u32 s30, s40, 81920
  buffer_load_dwordx4 v10, s[4:7], s30 offen lds
  s_mov_b32 m0, 25600
  s_add_u32 s30, s40, 92160
  buffer_load_dwordx4 v11, s[4:7], s30 offen lds
  s_mov_b32 m0, 26624
  s_add_u32 s30, s40, 102400
  buffer_load_dwordx4 v10, s[4:7], s30 offen lds
  s_mov_b32 m0, 27648
  s_add_u32 s30, s40, 112640
  buffer_load_dwordx4 v11, s[4:7], s30 offen lds
  s_mov_b32 m0, 28672
  s_add_u32 s30, s40, 122880
  buffer_load_dwordx4 v10, s[4:7], s30 offen lds
  s_mov_b32 m0, 29696
  s_add_u32 s30, s40, 133120
  buffer_load_dwordx4 v11, s[4:7], s30 offen lds
  s_mov_b32 m0, 30720
  s_add_u32 s30, s40, 143360
  buffer_load_dwordx4 v10, s[4:7], s30 offen lds
  s_mov_b32 m0, 31744
  s_add_u32 s30, s40, 153600
  buffer_load_dwordx4 v11, s[4:7], s30 offen lds
  s_add_u32 s40, s40, 128
  s_cmp_eq_u32 s40, 1280
  s_cselect_b32 s40, 0, s40
  s_waitcnt vmcnt(16)
  s_barrier
  s_mov_b32 m0, 32768
  s_add_u32 s30, s40, 0
  buffer_load_dwordx4 v10, s[4:7], s30 offen lds
  s_mov_b32 m0, 33792
  s_add_u32 s30, s40, 10240
  buffer_load_dwordx4 v11, s[4:7], s30 offen lds
  s_mov_b32 m0, 34816
  s_add_u32 s30, s40, 20480
  buffer_load_dwordx4 v10, s[4:7], s30 offen lds
  s_mov_b32 m0, 35840
  s_add_u32 s30, s40, 30720
  buffer_load_dwordx4 v11, s[4:7], s30 offen lds
  s_mov_b32 m0, 36864
  s_add_u32 s30, s40, 40960
  buffer_load_dwordx4 v10, s[4:7], s30 offen lds
  s_mov_b32 m0, 37888
  s_add_u32 s30, s40, 51200
  buffer_load_dwordx4 v11, s[4:7], s30 offen lds
  s_mov_b32 m0, 38912
  s_add_u32 s30, s40, 61440
  buffer_load_dwordx4 v10, s[4:7], s30 offen lds
  s_mov_b32 m0, 39936
  s_add_u32 s30, s40, 71680
  buffer_load_dwordx4 v11, s[4:7], s30 offen lds
  s_mov_b32 m0, 40960
  s_add_u32 s30, s40, 81920
  buffer_load_dwordx4 v10, s[4:7], s30 offen lds
  s_mov_b32 m0, 41984
  s_add_u32 s30, s40, 92160
  buffer_load_dwordx4 v11, s[4:7], s30 offen lds
  s_mov_b32 m0, 43008
  s_add_u32 s30, s40, 102400
  buffer_load_dwordx4 v10, s[4:7], s30 offen lds
  s_mov_b32 m0, 44032
  s_add_u32 s30, s40, 112640
  buffer_load_dwordx4 v11, s[4:7], s30 offen lds
  s_mov_b32 m0, 45056
  s_add_u32 s30, s40, 122880
  buffer_load_dwordx4 v10, s[4:7], s30 offen lds
  s_mov_b32 m0, 46080
  s_add_u32 s30, s40, 133120
  buffer_load_dwordx4 v11, s[4:7], s30 offen lds
  s_mov_b32 m0, 47104
  s_add_u32 s30, s40, 143360
  buffer_load_dwordx4 v10, s[4:7], s30 offen lds
  s_mov_b32 m0, 48128
  s_add_u32 s30, s40, 153600
  buffer_load_dwordx4 v11, s[4:7], s30 offen lds
  s_add_u32 s40, s40, 128
  s_cmp_eq_u32 s40, 1280
  s_cselect_b32 s40, 0, s40
  s_waitcnt vmcnt(16)
  s_barrier
  s_mov_b32 m0, 49152
  s_add_u32 s30, s40, 0
  buffer_load_dwordx4 v10, s[4:7], s30 offen lds
  s_mov_b32 m0, 50176
  s_add_u32 s30, s40, 10240
  buffer_load_dwordx4 v11, s[4:7], s30 offen lds
  s_mov_b32 m0, 51200
  s_add_u32 s30, s40, 20480
  buffer_load_dwordx4 v10, s[4:7], s30 offen lds
  s_mov_b32 m0, 52224
  s_add_u32 s30, s40, 30720
  buffer_load_dwordx4 v11, s[4:7], s30 offen lds
  s_mov_b32 m0, 53248
  s_add_u32 s30, s40, 40960
  buffer_load_dwordx4 v10, s[4:7], s30 offen lds
  s_mov_b32 m0, 54272
  s_add_u32 s30, s40, 51200
  buffer_load_dwordx4 v11, s[4:7], s30 offen lds
  s_mov_b32 m0, 55296
  s_add_u32 s30, s40, 61440
  buffer_load_dwordx4 v10, s[4:7], s30 offen lds
  s_mov_b32 m0, 56320
  s_add_u32 s30, s40, 71680
  buffer_load_dwordx4 v11, s[4:7], s30 offen lds
  s_mov_b32 m0, 57344
  s_add_u32 s30, s40, 81920
  buffer_load_dwordx4 v10, s[4:7], s30 offen lds
  s_mov_b32 m0, 58368
  s_add_u32 s30, s40, 92160
  buffer_load_dwordx4 v11, s[4:7], s30 offen lds
  s_mov_b32 m0, 59392
  s_add_u32 s30, s40, 102400
  buffer_load_dwordx4 v10, s[4:7], s30 offen lds
  s_mov_b32 m0, 60416
  s_add_u32 s30, s40, 112640
  buffer_load_dwordx4 v11, s[4:7], s30 offen lds
  s_mov_b32 m0, 61440
  s_add_u32 s30, s40, 122880
  buffer_load_dwordx4 v10, s[4:7], s30 offen lds
  s_mov_b32 m0, 62464
  s_add_u32 s30, s40, 133120
  buffer_load_dwordx4 v11, s[4:7], s30 offen lds
  s_mov_b32 m0, 63488
  s_add_u32 s30, s40, 143360
  buffer_load_dwordx4 v10, s[4:7], s30 offen lds
  s_mov_b32 m0, 64512
  s_add_u32 s30, s40, 153600
  buffer_load_dwordx4 v11, s[4:7], s30 offen lds
  s_add_u32 s40, s40, 128
  s_cmp_eq_u32 s40, 1280
  s_cselect_b32 s40, 0, s40
  s_waitcnt vmcnt(16)
  s_barrier
  s_mov_b32 m0, 0
  s_add_u32 s30, s40, 0
  buffer_load_dwordx4 v10, s[4:7], s30 offen lds
  s_mov_b32 m0, 1024
  s_add_u32 s30, s40, 10240
  buffer_load_dwordx4 v11, s[4:7], s30 offen lds
  s_mov_b32 m0, 2048
  s_add_u32 s30, s40, 20480
  buffer_load_dwordx4 v10, s[4:7], s30 offen lds
  s_mov_b32 m0, 3072
  s_add_u32 s30, s40, 30720
  buffer_load_dwordx4 v11, s[4:7], s30 offen lds
  s_mov_b32 m0, 4096
  s_add_u32 s30, s40, 40960
  buffer_load_dwordx4 v10, s[4:7], s30 offen lds
  s_mov_b32 m0, 5120
  s_add_u32 s30, s40, 51200
  buffer_load_dwordx4 v11, s[4:7], s30 offen lds
  s_mov_b32 m0, 6144
  s_add_u32 s30, s40, 61440
  buffer_load_dwordx4 v10, s[4:7], s30 offen lds
  s_mov_b32 m0, 7168
  s_add_u32 s30, s40, 71680
  buffer_load_dwordx4 v11, s[4:7], s30 offen lds
  s_mov_b32 m0, 8192
  s_add_u32 s30, s40, 81920
  buffer_load_dwordx4 v10, s[4:7], s30 offen lds
  s_mov_b32 m0, 9216
  s_add_u32 s30, s40, 92160
  buffer_load_dwordx4 v11, s[4:7], s30 offen lds
  s_mov_b32 m0, 10240
  s_add_u32 s30, s40, 102400
  buffer_load_dwordx4 v10, s[4:7], s30 offen lds
  s_mov_b32 m0, 11264
  s_add_u32 s30, s40, 112640
  buffer_load_dwordx4 v11, s[4:7], s30 offen lds
  s_mov_b32 m0, 12288
  s_add_u32 s30, s40, 122880
  buffer_load_dwordx4 v10, s[4:7], s30 offen lds
  s_mov_b32 m0, 13312
  s_add_u32 s30, s40, 133120
  buffer_load_dwordx4 v11, s[4:7], s30 offen lds
  s_mov_b32 m0, 14336
  s_add_u32 s30, s40, 143360
  buffer_load_dwordx4 v10, s[4:7], s30 offen lds
  s_mov_b32 m0, 15360
  s_add_u32 s30, s40, 153600
  buffer_load_dwordx4 v11, s[4:7], s30 offen lds
  s_add_u32 s40, s40, 128
  s_cmp_eq_u32 s40, 1280
  s_cselect_b32 s40, 0, s40
  s_waitcnt vmcnt(16)
  s_barrier
  s_mov_b32 m0, 16384
  s_add_u32 s30, s40, 0
  buffer_load_dwordx4 v10, s[4:7], s30 offen lds
  s_mov_b32 m0, 17408
  s_add_u32 s30, s40, 10240
  buffer_load_dwordx4 v11, s[4:7], s30 offen lds
  s_mov_b32 m0, 18432
  s_add_u32 s30, s40, 20480
  buffer_load_dwordx4 v10, s[4:7], s30 offen lds
  s_mov_b32 m0, 19456
  s_add_u32 s30, s40, 30720
  buffer_load_dwordx4 v11, s[4:7], s30 offen lds
  s_mov_b32 m0, 20480
  s_add_u32 s30, s40, 40960
  buffer_load_dwordx4 v10, s[4:7], s30 offen lds
  s_mov_b32 m0, 21504
  s_add_u32 s30, s40, 51200
  buffer_load_dwordx4 v11, s[4:7], s30 offen lds
  s_mov_b32 m0, 22528
  s_add_u32 s30, s40, 61440
  buffer_load_dwordx4 v10, s[4:7], s30 offen lds
  s_mov_b32 m0, 23552
  s_add_u32 s30, s40, 71680
  buffer_load_dwordx4 v11, s[4:7], s30 offen lds
  s_mov_b32 m0, 24576
  s_add_u32 s30, s40, 81920
  buffer_load_dwordx4 v10, s[4:7], s30 offen lds
  s_mov_b32 m0, 25600
  s_add_u32 s30, s40, 92160
  buffer_load_dwordx4 v11, s[4:7], s30 offen lds
  s_mov_b32 m0, 26624
  s_add_u32 s30, s40, 102400
  buffer_load_dwordx4 v10, s[4:7], s30 offen lds
  s_mov_b32 m0, 27648
  s_add_u32 s30, s40, 112640
  buffer_load_dwordx4 v11, s[4:7], s30 offen lds
  s_mov_b32 m0, 28672
  s_add_u32 s30, s40, 122880
  buffer_load_dwordx4 v10, s[4:7], s30 offen lds
  s_mov_b32 m0, 29696
  s_add_u32 s30, s40, 133120
  buffer_load_dwordx4 v11, s[4:7], s30 offen lds
  s_mov_b32 m0, 30720
  s_add_u32 s30, s40, 143360
  buffer_load_dwordx4 v10, s[4:7], s30 offen lds
  s_mov_b32 m0, 31744
  s_add_u32 s30, s40, 153600
  buffer_load_dwordx4 v11, s[4:7], s30 offen lds
  s_add_u32 s40, s40, 128
  s_cmp_eq_u32 s40, 1280
  s_cselect_b32 s40, 0, s40
  s_waitcnt vmcnt(16)
  s_barrier
  s_waitcnt vmcnt(0)
  s_barrier
  s_mov_b64 exec, -1
  s_cmp_ge_u32 s2, 240
  s_cbranch_scc1 L_mx_21
  s_min_u32 s43, s2, 239
  v_bfe_u32 v12, v1, 4, 1
  v_lshlrev_b32 v12, 1, v12
  v_and_b32 v13, 7, v1
  v_xor_b32 v12, v12, v13
  v_lshlrev_b32 v12, 4, v12
  v_xor_b32 v13, 64, v12
  v_lshrrev_b32 v14, 3, v1
  s_mul_i32 s29, s43, 171
  s_lshr_b32 s29, s29, 12
  s_mul_i32 s30, s29, 24
  s_sub_u32 s30, s43, s30
  s_mul_i32 s29, s29, 196608
  s_lshl_b32 s30, s30, 7
  s_add_u32 s29, s29, s30
  v_mul_u32_u24 v14, 3072, v14
  v_add_u32 v12, v12, v14
  v_add_u32 v13, v13, v14
  s_mov_b32 m0, 138240
  s_add_u32 s30, s29, 0
  buffer_load_dwordx4 v12, s[56:59], s30 offen lds
  s_mov_b32 m0, 139264
  s_add_u32 s30, s29, 24576
  buffer_load_dwordx4 v13, s[56:59], s30 offen lds
  s_mov_b32 m0, 140288
  s_add_u32 s30, s29, 49152
  buffer_load_dwordx4 v12, s[56:59], s30 offen lds
  s_mov_b32 m0, 141312
  s_add_u32 s30, s29, 73728
  buffer_load_dwordx4 v13, s[56:59], s30 offen lds
  s_mov_b32 m0, 142336
  s_add_u32 s30, s29, 98304
  buffer_load_dwordx4 v12, s[56:59], s30 offen lds
  s_mov_b32 m0, 143360
  s_add_u32 s30, s29, 122880
  buffer_load_dwordx4 v13, s[56:59], s30 offen lds
  s_mov_b32 m0, 144384
  s_add_u32 s30, s29, 147456
  buffer_load_dwordx4 v12, s[56:59], s30 offen lds
  s_mov_b32 m0, 145408
  s_add_u32 s30, s29, 172032
  buffer_load_dwordx4 v13, s[56:59], s30 offen lds
  s_mov_b32 m0, 146432
  s_add_u32 s30, s29, 0
  buffer_load_dwordx4 v12, s[92:95], s30 offen lds
  s_mov_b32 m0, 147456
  s_add_u32 s30, s29, 24576
  buffer_load_dwordx4 v13, s[92:95], s30 offen lds
  s_mov_b32 m0, 148480
  s_add_u32 s30, s29, 49152
  buffer_load_dwordx4 v12, s[92:95], s30 offen lds
  s_mov_b32 m0, 149504
  s_add_u32 s30, s29, 73728
  buffer_load_dwordx4 v13, s[92:95], s30 offen lds
  s_mov_b32 m0, 150528
  s_add_u32 s30, s29, 98304
  buffer_load_dwordx4 v12, s[92:95], s30 offen lds
  s_mov_b32 m0, 151552
  s_add_u32 s30, s29, 122880
  buffer_load_dwordx4 v13, s[92:95], s30 offen lds
  s_mov_b32 m0, 152576
  s_add_u32 s30, s29, 147456
  buffer_load_dwordx4 v12, s[92:95], s30 offen lds
  s_mov_b32 m0, 153600
  s_add_u32 s30, s29, 172032
  buffer_load_dwordx4 v13, s[92:95], s30 offen lds
L_mx_21:
  s_branch L_l_j
L_l_r1:
  s_mov_b64 exec, s[24:25]
  s_mov_b32 m0, 65536
  s_add_u32 s30, s40, 0
  buffer_load_dwordx4 v10, s[8:11], s30 offen lds
  s_mov_b32 m0, 66560
  s_add_u32 s30, s40, 15360
  buffer_load_dwordx4 v11, s[8:11], s30 offen lds
  s_mov_b32 m0, 67584
  s_add_u32 s30, s40, 30720
  buffer_load_dwordx4 v10, s[8:11], s30 offen lds
  s_mov_b32 m0, 68608
  s_add_u32 s30, s40, 46080
  buffer_load_dwordx4 v11, s[8:11], s30 offen lds
  s_mov_b32 m0, 69632
  s_add_u32 s30, s40, 61440
  buffer_load_dwordx4 v10, s[8:11], s30 offen lds
  s_mov_b32 m0, 70656
  s_add_u32 s30, s40, 76800
  buffer_load_dwordx4 v11, s[8:11], s30 offen lds
  s_mov_b32 m0, 71680
  s_add_u32 s30, s40, 92160
  buffer_load_dwordx4 v10, s[8:11], s30 offen lds
  s_mov_b32 m0, 72704
  s_add_u32 s30, s40, 107520
  buffer_load_dwordx4 v11, s[8:11], s30 offen lds
  s_mov_b32 m0, 73728
  s_add_u32 s30, s40, 122880
  buffer_load_dwordx4 v10, s[8:11], s30 offen lds
  s_mov_b32 m0, 74752
  s_add_u32 s30, s40, 138240
  buffer_load_dwordx4 v11, s[8:11], s30 offen lds
  s_mov_b32 m0, 75776
  s_add_u32 s30, s40, 153600
  buffer_load_dwordx4 v10, s[8:11], s30 offen lds
  s_mov_b32 m0, 76800
  s_add_u32 s30, s40, 168960
  buffer_load_dwordx4 v11, s[8:11], s30 offen lds
  s_mov_b32 m0, 77824
  s_add_u32 s30, s40, 184320
  buffer_load_dwordx4 v10, s[8:11], s30 offen lds
  s_mov_b32 m0, 78848
  s_add_u32 s30, s40, 199680
  buffer_load_dwordx4 v11, s[8:11], s30 offen lds
  s_mov_b32 m0, 79872
  s_add_u32 s30, s40, 215040
  buffer_load_dwordx4 v10, s[8:11], s30 offen lds
  s_mov_b32 m0, 80896
  s_add_u32 s30, s40, 230400
  buffer_load_dwordx4 v11, s[8:11], s30 offen lds
  s_add_u32 s40, s40, 245760
  s_cmp_eq_u32 s40, 2457600
  s_cselect_b32 s40, 0, s40
  s_mov_b32 m0, 81920
  s_add_u32 s30, s40, 0
  buffer_load_dwordx4 v10, s[8:11], s30 offen lds
  s_mov_b32 m0, 82944
  s_add_u32 s30, s40, 15360
  buffer_load_dwordx4 v11, s[8:11], s30 offen lds
  s_mov_b32 m0, 83968
  s_add_u32 s30, s40, 30720
  buffer_load_dwordx4 v10, s[8:11], s30 offen lds
  s_mov_b32 m0, 84992
  s_add_u32 s30, s40, 46080
  buffer_load_dwordx4 v11, s[8:11], s30 offen lds
  s_mov_b32 m0, 86016
  s_add_u32 s30, s40, 61440
  buffer_load_dwordx4 v10, s[8:11], s30 offen lds
  s_mov_b32 m0, 87040
  s_add_u32 s30, s40, 76800
  buffer_load_dwordx4 v11, s[8:11], s30 offen lds
  s_mov_b32 m0, 88064
  s_add_u32 s30, s40, 92160
  buffer_load_dwordx4 v10, s[8:11], s30 offen lds
  s_mov_b32 m0, 89088
  s_add_u32 s30, s40, 107520
  buffer_load_dwordx4 v11, s[8:11], s30 offen lds
  s_mov_b32 m0, 90112
  s_add_u32 s30, s40, 122880
  buffer_load_dwordx4 v10, s[8:11], s30 offen lds
  s_mov_b32 m0, 91136
  s_add_u32 s30, s40, 138240
  buffer_load_dwordx4 v11, s[8:11], s30 offen lds
  s_mov_b32 m0, 92160
  s_add_u32 s30, s40, 153600
  buffer_load_dwordx4 v10, s[8:11], s30 offen lds
  s_mov_b32 m0, 93184
  s_add_u32 s30, s40, 168960
  buffer_load_dwordx4 v11, s[8:11], s30 offen lds
  s_mov_b32 m0, 94208
  s_add_u32 s30, s40, 184320
  buffer_load_dwordx4 v10, s[8:11], s30 offen lds
  s_mov_b32 m0, 95232
  s_add_u32 s30, s40, 199680
  buffer_load_dwordx4 v11, s[8:11], s30 offen lds
  s_mov_b32 m0, 96256
  s_add_u32 s30, s40, 215040
  buffer_load_dwordx4 v10, s[8:11], s30 offen lds
  s_mov_b32 m0, 97280
  s_add_u32 s30, s40, 230400
  buffer_load_dwordx4 v11, s[8:11], s30 offen lds
  s_add_u32 s40, s40, 245760
  s_cmp_eq_u32 s40, 2457600
  s_cselect_b32 s40, 0, s40
  s_waitcnt vmcnt(16)
  s_barrier
  s_mov_b32 m0, 98304
  s_add_u32 s30, s40, 0
  buffer_load_dwordx4 v10, s[8:11], s30 offen lds
  s_mov_b32 m0, 99328
  s_add_u32 s30, s40, 15360
  buffer_load_dwordx4 v11, s[8:11], s30 offen lds
  s_mov_b32 m0, 100352
  s_add_u32 s30, s40, 30720
  buffer_load_dwordx4 v10, s[8:11], s30 offen lds
  s_mov_b32 m0, 101376
  s_add_u32 s30, s40, 46080
  buffer_load_dwordx4 v11, s[8:11], s30 offen lds
  s_mov_b32 m0, 102400
  s_add_u32 s30, s40, 61440
  buffer_load_dwordx4 v10, s[8:11], s30 offen lds
  s_mov_b32 m0, 103424
  s_add_u32 s30, s40, 76800
  buffer_load_dwordx4 v11, s[8:11], s30 offen lds
  s_mov_b32 m0, 104448
  s_add_u32 s30, s40, 92160
  buffer_load_dwordx4 v10, s[8:11], s30 offen lds
  s_mov_b32 m0, 105472
  s_add_u32 s30, s40, 107520
  buffer_load_dwordx4 v11, s[8:11], s30 offen lds
  s_mov_b32 m0, 106496
  s_add_u32 s30, s40, 122880
  buffer_load_dwordx4 v10, s[8:11], s30 offen lds
  s_mov_b32 m0, 107520
  s_add_u32 s30, s40, 138240
  buffer_load_dwordx4 v11, s[8:11], s30 offen lds
  s_mov_b32 m0, 108544
  s_add_u32 s30, s40, 153600
  buffer_load_dwordx4 v10, s[8:11], s30 offen lds
  s_mov_b32 m0, 109568
  s_add_u32 s30, s40, 168960
  buffer_load_dwordx4 v11, s[8:11], s30 offen lds
  s_mov_b32 m0, 110592
  s_add_u32 s30, s40, 184320
  buffer_load_dwordx4 v10, s[8:11], s30 offen lds
  s_mov_b32 m0, 111616
  s_add_u32 s30, s40, 199680
  buffer_load_dwordx4 v11, s[8:11], s30 offen lds
  s_mov_b32 m0, 112640
  s_add_u32 s30, s40, 215040
  buffer_load_dwordx4 v10, s[8:11], s30 offen lds
  s_mov_b32 m0, 113664
  s_add_u32 s30, s40, 230400
  buffer_load_dwordx4 v11, s[8:11], s30 offen lds
  s_add_u32 s40, s40, 245760
  s_cmp_eq_u32 s40, 2457600
  s_cselect_b32 s40, 0, s40
  s_waitcnt vmcnt(16)
  s_barrier
  s_mov_b32 m0, 114688
  s_add_u32 s30, s40, 0
  buffer_load_dwordx4 v10, s[8:11], s30 offen lds
  s_mov_b32 m0, 115712
  s_add_u32 s30, s40, 15360
  buffer_load_dwordx4 v11, s[8:11], s30 offen lds
  s_mov_b32 m0, 116736
  s_add_u32 s30, s40, 30720
  buffer_load_dwordx4 v10, s[8:11], s30 offen lds
  s_mov_b32 m0, 117760
  s_add_u32 s30, s40, 46080
  buffer_load_dwordx4 v11, s[8:11], s30 offen lds
  s_mov_b32 m0, 118784
  s_add_u32 s30, s40, 61440
  buffer_load_dwordx4 v10, s[8:11], s30 offen lds
  s_mov_b32 m0, 119808
  s_add_u32 s30, s40, 76800
  buffer_load_dwordx4 v11, s[8:11], s30 offen lds
  s_mov_b32 m0, 120832
  s_add_u32 s30, s40, 92160
  buffer_load_dwordx4 v10, s[8:11], s30 offen lds
  s_mov_b32 m0, 121856
  s_add_u32 s30, s40, 107520
  buffer_load_dwordx4 v11, s[8:11], s30 offen lds
  s_mov_b32 m0, 122880
  s_add_u32 s30, s40, 122880
  buffer_load_dwordx4 v10, s[8:11], s30 offen lds
  s_mov_b32 m0, 123904
  s_add_u32 s30, s40, 138240
  buffer_load_dwordx4 v11, s[8:11], s30 offen lds
  s_mov_b32 m0, 124928
  s_add_u32 s30, s40, 153600
  buffer_load_dwordx4 v10, s[8:11], s30 offen lds
  s_mov_b32 m0, 125952
  s_add_u32 s30, s40, 168960
  buffer_load_dwordx4 v11, s[8:11], s30 offen lds
  s_mov_b32 m0, 126976
  s_add_u32 s30, s40, 184320
  buffer_load_dwordx4 v10, s[8:11], s30 offen lds
  s_mov_b32 m0, 128000
  s_add_u32 s30, s40, 199680
  buffer_load_dwordx4 v11, s[8:11], s30 offen lds
  s_mov_b32 m0, 129024
  s_add_u32 s30, s40, 215040
  buffer_load_dwordx4 v10, s[8:11], s30 offen lds
  s_mov_b32 m0, 130048
  s_add_u32 s30, s40, 230400
  buffer_load_dwordx4 v11, s[8:11], s30 offen lds
  s_add_u32 s40, s40, 245760
  s_cmp_eq_u32 s40, 2457600
  s_cselect_b32 s40, 0, s40
  s_waitcnt vmcnt(16)
  s_barrier
  s_mov_b32 m0, 65536
  s_add_u32 s30, s40, 0
  buffer_load_dwordx4 v10, s[8:11], s30 offen lds
  s_mov_b32 m0, 66560
  s_add_u32 s30, s40, 15360
  buffer_load_dwordx4 v11, s[8:11], s30 offen lds
  s_mov_b32 m0, 67584
  s_add_u32 s30, s40, 30720
  buffer_load_dwordx4 v10, s[8:11], s30 offen lds
  s_mov_b32 m0, 68608
  s_add_u32 s30, s40, 46080
  buffer_load_dwordx4 v11, s[8:11], s30 offen lds
  s_mov_b32 m0, 69632
  s_add_u32 s30, s40, 61440
  buffer_load_dwordx4 v10, s[8:11], s30 offen lds
  s_mov_b32 m0, 70656
  s_add_u32 s30, s40, 76800
  buffer_load_dwordx4 v11, s[8:11], s30 offen lds
  s_mov_b32 m0, 71680
  s_add_u32 s30, s40, 92160
  buffer_load_dwordx4 v10, s[8:11], s30 offen lds
  s_mov_b32 m0, 72704
  s_add_u32 s30, s40, 107520
  buffer_load_dwordx4 v11, s[8:11], s30 offen lds
  s_mov_b32 m0, 73728
  s_add_u32 s30, s40, 122880
  buffer_load_dwordx4 v10, s[8:11], s30 offen lds
  s_mov_b32 m0, 74752
  s_add_u32 s30, s40, 138240
  buffer_load_dwordx4 v11, s[8:11], s30 offen lds
  s_mov_b32 m0, 75776
  s_add_u32 s30, s40, 153600
  buffer_load_dwordx4 v10, s[8:11], s30 offen lds
  s_mov_b32 m0, 76800
  s_add_u32 s30, s40, 168960
  buffer_load_dwordx4 v11, s[8:11], s30 offen lds
  s_mov_b32 m0, 77824
  s_add_u32 s30, s40, 184320
  buffer_load_dwordx4 v10, s[8:11], s30 offen lds
  s_mov_b32 m0, 78848
  s_add_u32 s30, s40, 199680
  buffer_load_dwordx4 v11, s[8:11], s30 offen lds
  s_mov_b32 m0, 79872
  s_add_u32 s30, s40, 215040
  buffer_load_dwordx4 v10, s[8:11], s30 offen lds
  s_mov_b32 m0, 80896
  s_add_u32 s30, s40, 230400
  buffer_load_dwordx4 v11, s[8:11], s30 offen lds
  s_add_u32 s40, s40, 245760
  s_cmp_eq_u32 s40, 2457600
  s_cselect_b32 s40, 0, s40
  s_waitcnt vmcnt(16)
  s_barrier
  s_mov_b32 m0, 81920
  s_add_u32 s30, s40, 0
  buffer_load_dwordx4 v10, s[8:11], s30 offen lds
  s_mov_b32 m0, 82944
  s_add_u32 s30, s40, 15360
  buffer_load_dwordx4 v11, s[8:11], s30 offen lds
  s_mov_b32 m0, 83968
  s_add_u32 s30, s40, 30720
  buffer_load_dwordx4 v10, s[8:11], s30 offen lds
  s_mov_b32 m0, 84992
  s_add_u32 s30, s40, 46080
  buffer_load_dwordx4 v11, s[8:11], s30 offen lds
  s_mov_b32 m0, 86016
  s_add_u32 s30, s40, 61440
  buffer_load_dwordx4 v10, s[8:11], s30 offen lds
  s_mov_b32 m0, 87040
  s_add_u32 s30, s40, 76800
  buffer_load_dwordx4 v11, s[8:11], s30 offen lds
  s_mov_b32 m0, 88064
  s_add_u32 s30, s40, 92160
  buffer_load_dwordx4 v10, s[8:11], s30 offen lds
  s_mov_b32 m0, 89088
  s_add_u32 s30, s40, 107520
  buffer_load_dwordx4 v11, s[8:11], s30 offen lds
  s_mov_b32 m0, 90112
  s_add_u32 s30, s40, 122880
  buffer_load_dwordx4 v10, s[8:11], s30 offen lds
  s_mov_b32 m0, 91136
  s_add_u32 s30, s40, 138240
  buffer_load_dwordx4 v11, s[8:11], s30 offen lds
  s_mov_b32 m0, 92160
  s_add_u32 s30, s40, 153600
  buffer_load_dwordx4 v10, s[8:11], s30 offen lds
  s_mov_b32 m0, 93184
  s_add_u32 s30, s40, 168960
  buffer_load_dwordx4 v11, s[8:11], s30 offen lds
  s_mov_b32 m0, 94208
  s_add_u32 s30, s40, 184320
  buffer_load_dwordx4 v10, s[8:11], s30 offen lds
  s_mov_b32 m0, 95232
  s_add_u32 s30, s40, 199680
  buffer_load_dwordx4 v11, s[8:11], s30 offen lds
  s_mov_b32 m0, 96256
  s_add_u32 s30, s40, 215040
  buffer_load_dwordx4 v10, s[8:11], s30 offen lds
  s_mov_b32 m0, 97280
  s_add_u32 s30, s40, 230400
  buffer_load_dwordx4 v11, s[8:11], s30 offen lds
  s_add_u32 s40, s40, 245760
  s_cmp_eq_u32 s40, 2457600
  s_cselect_b32 s40, 0, s40
  s_waitcnt vmcnt(16)
  s_barrier
  s_mov_b32 m0, 98304
  s_add_u32 s30, s40, 0
  buffer_load_dwordx4 v10, s[8:11], s30 offen lds
  s_mov_b32 m0, 99328
  s_add_u32 s30, s40, 15360
  buffer_load_dwordx4 v11, s[8:11], s30 offen lds
  s_mov_b32 m0, 100352
  s_add_u32 s30, s40, 30720
  buffer_load_dwordx4 v10, s[8:11], s30 offen lds
  s_mov_b32 m0, 101376
  s_add_u32 s30, s40, 46080
  buffer_load_dwordx4 v11, s[8:11], s30 offen lds
  s_mov_b32 m0, 102400
  s_add_u32 s30, s40, 61440
  buffer_load_dwordx4 v10, s[8:11], s30 offen lds
  s_mov_b32 m0, 103424
  s_add_u32 s30, s40, 76800
  buffer_load_dwordx4 v11, s[8:11], s30 offen lds
  s_mov_b32 m0, 104448
  s_add_u32 s30, s40, 92160
  buffer_load_dwordx4 v10, s[8:11], s30 offen lds
  s_mov_b32 m0, 105472
  s_add_u32 s30, s40, 107520
  buffer_load_dwordx4 v11, s[8:11], s30 offen lds
  s_mov_b32 m0, 106496
  s_add_u32 s30, s40, 122880
  buffer_load_dwordx4 v10, s[8:11], s30 offen lds
  s_mov_b32 m0, 107520
  s_add_u32 s30, s40, 138240
  buffer_load_dwordx4 v11, s[8:11], s30 offen lds
  s_mov_b32 m0, 108544
  s_add_u32 s30, s40, 153600
  buffer_load_dwordx4 v10, s[8:11], s30 offen lds
  s_mov_b32 m0, 109568
  s_add_u32 s30, s40, 168960
  buffer_load_dwordx4 v11, s[8:11], s30 offen lds
  s_mov_b32 m0, 110592
  s_add_u32 s30, s40, 184320
  buffer_load_dwordx4 v10, s[8:11], s30 offen lds
  s_mov_b32 m0, 111616
  s_add_u32 s30, s40, 199680
  buffer_load_dwordx4 v11, s[8:11], s30 offen lds
  s_mov_b32 m0, 112640
  s_add_u32 s30, s40, 215040
  buffer_load_dwordx4 v10, s[8:11], s30 offen lds
  s_mov_b32 m0, 113664
  s_add_u32 s30, s40, 230400
  buffer_load_dwordx4 v11, s[8:11], s30 offen lds
  s_add_u32 s40, s40, 245760
  s_cmp_eq_u32 s40, 2457600
  s_cselect_b32 s40, 0, s40
  s_waitcnt vmcnt(16)
  s_barrier
  s_mov_b32 m0, 114688
  s_add_u32 s30, s40, 0
  buffer_load_dwordx4 v10, s[8:11], s30 offen lds
  s_mov_b32 m0, 115712
  s_add_u32 s30, s40, 15360
  buffer_load_dwordx4 v11, s[8:11], s30 offen lds
  s_mov_b32 m0, 116736
  s_add_u32 s30, s40, 30720
  buffer_load_dwordx4 v10, s[8:11], s30 offen lds
  s_mov_b32 m0, 117760
  s_add_u32 s30, s40, 46080
  buffer_load_dwordx4 v11, s[8:11], s30 offen lds
  s_mov_b32 m0, 118784
  s_add_u32 s30, s40, 61440
  buffer_load_dwordx4 v10, s[8:11], s30 offen lds
  s_mov_b32 m0, 119808
  s_add_u32 s30, s40, 76800
  buffer_load_dwordx4 v11, s[8:11], s30 offen lds
  s_mov_b32 m0, 120832
  s_add_u32 s30, s40, 92160
  buffer_load_dwordx4 v10, s[8:11], s30 offen lds
  s_mov_b32 m0, 121856
  s_add_u32 s30, s40, 107520
  buffer_load_dwordx4 v11, s[8:11], s30 offen lds
  s_mov_b32 m0, 122880
  s_add_u32 s30, s40, 122880
  buffer_load_dwordx4 v10, s[8:11], s30 offen lds
  s_mov_b32 m0, 123904
  s_add_u32 s30, s40, 138240
  buffer_load_dwordx4 v11, s[8:11], s30 offen lds
  s_mov_b32 m0, 124928
  s_add_u32 s30, s40, 153600
  buffer_load_dwordx4 v10, s[8:11], s30 offen lds
  s_mov_b32 m0, 125952
  s_add_u32 s30, s40, 168960
  buffer_load_dwordx4 v11, s[8:11], s30 offen lds
  s_mov_b32 m0, 126976
  s_add_u32 s30, s40, 184320
  buffer_load_dwordx4 v10, s[8:11], s30 offen lds
  s_mov_b32 m0, 128000
  s_add_u32 s30, s40, 199680
  buffer_load_dwordx4 v11, s[8:11], s30 offen lds
  s_mov_b32 m0, 129024
  s_add_u32 s30, s40, 215040
  buffer_load_dwordx4 v10, s[8:11], s30 offen lds
  s_mov_b32 m0, 130048
  s_add_u32 s30, s40, 230400
  buffer_load_dwordx4 v11, s[8:11], s30 offen lds
  s_add_u32 s40, s40, 245760
  s_cmp_eq_u32 s40, 2457600
  s_cselect_b32 s40, 0, s40
  s_waitcnt vmcnt(16)
  s_barrier
  s_mov_b32 m0, 65536
  s_add_u32 s30, s40, 0
  buffer_load_dwordx4 v10, s[8:11], s30 offen lds
  s_mov_b32 m0, 66560
  s_add_u32 s30, s40, 15360
  buffer_load_dwordx4 v11, s[8:11], s30 offen lds
  s_mov_b32 m0, 67584
  s_add_u32 s30, s40, 30720
  buffer_load_dwordx4 v10, s[8:11], s30 offen lds
  s_mov_b32 m0, 68608
  s_add_u32 s30, s40, 46080
  buffer_load_dwordx4 v11, s[8:11], s30 offen lds
  s_mov_b32 m0, 69632
  s_add_u32 s30, s40, 61440
  buffer_load_dwordx4 v10, s[8:11], s30 offen lds
  s_mov_b32 m0, 70656
  s_add_u32 s30, s40, 76800
  buffer_load_dwordx4 v11, s[8:11], s30 offen lds
  s_mov_b32 m0, 71680
  s_add_u32 s30, s40, 92160
  buffer_load_dwordx4 v10, s[8:11], s30 offen lds
  s_mov_b32 m0, 72704
  s_add_u32 s30, s40, 107520
  buffer_load_dwordx4 v11, s[8:11], s30 offen lds
  s_mov_b32 m0, 73728
  s_add_u32 s30, s40, 122880
  buffer_load_dwordx4 v10, s[8:11], s30 offen lds
  s_mov_b32 m0, 74752
  s_add_u32 s30, s40, 138240
  buffer_load_dwordx4 v11, s[8:11], s30 offen lds
  s_mov_b32 m0, 75776
  s_add_u32 s30, s40, 153600
  buffer_load_dwordx4 v10, s[8:11], s30 offen lds
  s_mov_b32 m0, 76800
  s_add_u32 s30, s40, 168960
  buffer_load_dwordx4 v11, s[8:11], s30 offen lds
  s_mov_b32 m0, 77824
  s_add_u32 s30, s40, 184320
  buffer_load_dwordx4 v10, s[8:11], s30 offen lds
  s_mov_b32 m0, 78848
  s_add_u32 s30, s40, 199680
  buffer_load_dwordx4 v11, s[8:11], s30 offen lds
  s_mov_b32 m0, 79872
  s_add_u32 s30, s40, 215040
  buffer_load_dwordx4 v10, s[8:11], s30 offen lds
  s_mov_b32 m0, 80896
  s_add_u32 s30, s40, 230400
  buffer_load_dwordx4 v11, s[8:11], s30 offen lds
  s_add_u32 s40, s40, 245760
  s_cmp_eq_u32 s40, 2457600
  s_cselect_b32 s40, 0, s40
  s_waitcnt vmcnt(16)
  s_barrier
  s_mov_b32 m0, 81920
  s_add_u32 s30, s40, 0
  buffer_load_dwordx4 v10, s[8:11], s30 offen lds
  s_mov_b32 m0, 82944
  s_add_u32 s30, s40, 15360
  buffer_load_dwordx4 v11, s[8:11], s30 offen lds
  s_mov_b32 m0, 83968
  s_add_u32 s30, s40, 30720
  buffer_load_dwordx4 v10, s[8:11], s30 offen lds
  s_mov_b32 m0, 84992
  s_add_u32 s30, s40, 46080
  buffer_load_dwordx4 v11, s[8:11], s30 offen lds
  s_mov_b32 m0, 86016
  s_add_u32 s30, s40, 61440
  buffer_load_dwordx4 v10, s[8:11], s30 offen lds
  s_mov_b32 m0, 87040
  s_add_u32 s30, s40, 76800
  buffer_load_dwordx4 v11, s[8:11], s30 offen lds
  s_mov_b32 m0, 88064
  s_add_u32 s30, s40, 92160
  buffer_load_dwordx4 v10, s[8:11], s30 offen lds
  s_mov_b32 m0, 89088
  s_add_u32 s30, s40, 107520
  buffer_load_dwordx4 v11, s[8:11], s30 offen lds
  s_mov_b32 m0, 90112
  s_add_u32 s30, s40, 122880
  buffer_load_dwordx4 v10, s[8:11], s30 offen lds
  s_mov_b32 m0, 91136
  s_add_u32 s30, s40, 138240
  buffer_load_dwordx4 v11, s[8:11], s30 offen lds
  s_mov_b32 m0, 92160
  s_add_u32 s30, s40, 153600
  buffer_load_dwordx4 v10, s[8:11], s30 offen lds
  s_mov_b32 m0, 93184
  s_add_u32 s30, s40, 168960
  buffer_load_dwordx4 v11, s[8:11], s30 offen lds
  s_mov_b32 m0, 94208
  s_add_u32 s30, s40, 184320
  buffer_load_dwordx4 v10, s[8:11], s30 offen lds
  s_mov_b32 m0, 95232
  s_add_u32 s30, s40, 199680
  buffer_load_dwordx4 v11, s[8:11], s30 offen lds
  s_mov_b32 m0, 96256
  s_add_u32 s30, s40, 215040
  buffer_load_dwordx4 v10, s[8:11], s30 offen lds
  s_mov_b32 m0, 97280
  s_add_u32 s30, s40, 230400
  buffer_load_dwordx4 v11, s[8:11], s30 offen lds
  s_add_u32 s40, s40, 245760
  s_cmp_eq_u32 s40, 2457600
  s_cselect_b32 s40, 0, s40
  s_waitcnt vmcnt(16)
  s_barrier
  s_waitcnt vmcnt(0)
  s_barrier
  s_mov_b64 exec, -1
  s_cmp_ge_u32 s2, 240
  s_cbranch_scc1 L_mx_22
  s_min_u32 s43, s2, 239
  v_bfe_u32 v12, v1, 4, 1
  v_lshlrev_b32 v12, 1, v12
  v_and_b32 v13, 7, v1
  v_xor_b32 v12, v12, v13
  v_lshlrev_b32 v12, 4, v12
  v_xor_b32 v13, 64, v12
  v_lshrrev_b32 v14, 3, v1
  s_mul_i32 s29, s43, 205
  s_lshr_b32 s29, s29, 11
  s_mul_i32 s30, s29, 10
  s_sub_u32 s30, s43, s30
  s_mul_i32 s29, s29, 81920
  s_lshl_b32 s30, s30, 7
  s_add_u32 s29, s29, s30
  v_mul_u32_u24 v14, 1280, v14
  v_add_u32 v12, v12, v14
  v_add_u32 v13, v13, v14
  s_mov_b32 m0, 154624
  s_add_u32 s30, s29, 0
  buffer_load_dwordx4 v12, s[56:59], s30 offen lds
  s_mov_b32 m0, 155648
  s_add_u32 s30, s29, 10240
  buffer_load_dwordx4 v13, s[56:59], s30 offen lds
  s_mov_b32 m0, 156672
  s_add_u32 s30, s29, 20480
  buffer_load_dwordx4 v12, s[56:59], s30 offen lds
  s_mov_b32 m0, 157696
  s_add_u32 s30, s29, 30720
  buffer_load_dwordx4 v13, s[56:59], s30 offen lds
  s_mov_b32 m0, 158720
  s_add_u32 s30, s29, 40960
  buffer_load_dwordx4 v12, s[56:59], s30 offen lds
  s_mov_b32 m0, 159744
  s_add_u32 s30, s29, 51200
  buffer_load_dwordx4 v13, s[56:59], s30 offen lds
  s_mov_b32 m0, 160768
  s_add_u32 s30, s29, 61440
  buffer_load_dwordx4 v12, s[56:59], s30 offen lds
  s_mov_b32 m0, 161792
  s_add_u32 s30, s29, 71680
  buffer_load_dwordx4 v13, s[56:59], s30 offen lds
L_mx_22:
L_l_j:
  s_barrier
  s_and_b32 s62, s18, 15
  s_lshl_b32 s29, s46, 4
  s_add_u32 s62, s62, s29
  s_lshr_b32 s63, s18, 4
  s_lshl_b32 s29, s47, 1
  s_add_u32 s63, s63, s29
  s_and_b32 s64, s62, 1
  s_mul_i32 s65, s62, 5
  s_lshr_b32 s65, s65, 1
  s_sub_u32 s36, 1, s21
  s_mul_i32 s32, s36, 80
  s_add_u32 s32, s32, 80
  s_add_u32 s32, s32, s65
  s_lshl_b32 s32, s32, 15
  s_add_u32 s32, s32, 1048576
  s_mul_i32 s33, s36, 24768
  s_lshl_b32 s31, s63, 8
  s_sub_u32 s31, s31, 256
  s_lshl_b32 s31, s31, 4
  s_add_u32 s32, s32, s31
  v_lshlrev_b32 v4, 4, v1
  v_add_u32 v7, s33, v4
  s_and_b32 s37, s63, 1
  s_xor_b32 s37, s37, 1
  s_cmp_eq_u32 s63, 0
  s_cselect_b32 s37, 0, s37
  s_mul_i32 s44, s36, 80
  s_add_u32 s44, s44, s65
  s_mul_i32 s44, s44, 12288
  s_lshr_b32 s45, s63, 1
  s_sub_u32 s45, s45, 1
  s_lshl_b32 s45, s45, 12
  s_add_u32 s44, s44, s45
  s_add_u32 s44, s44, 13631488
  s_sub_u32 s35, 1, s64
  s_mul_i32 s35, s35, 16520
  v_add_u32 v8, s35, v7
  v_mov_b32 v20, 0x3f803f80
  s_cmp_eq_u32 s36, 0
  s_cselect_b32 s35, 0, 0x3f803f80
  v_mov_b32 v21, s35
  v_mov_b32 v22, 0x3f803f80
  s_mov_b32 s34, 0x3f803f80
  s_cselect_b32 s35, 0xf149, s34
  v_mov_b32 v23, s35
  v_mov_b32 v24, 0
  v_mov_b32 v25, 0
  v_mov_b32 v26, 0
  v_mov_b32 v27, 0
  v_mov_b32 v5, 137472
  s_cmp_eq_u32 s21, 0
  s_cbranch_scc1 L_l_b0
  s_lshl_b32 s29, s46, 7
  s_lshl_b32 s30, s63, 4
  s_add_u32 s29, s29, s30
  s_sub_u32 s29, s29, 16
  s_lshl_b32 s29, s29, 6
  s_add_u32 s29, s29, 294912
  v_and_b32 v6, 31, v1
  s_cmp_eq_u32 s63, 0
  s_cselect_b32 s30, 16, 0
  v_max_u32 v6, s30, v6
  s_and_b32 s37, s63, 1
  s_xor_b32 s37, s37, 1
  s_cmp_eq_u32 s63, 0
  s_cselect_b32 s37, 0, s37
  v_and_b32 v10, 7, v6
  v_max_u32 v10, 2, v10
  v_and_b32 v11, 24, v6
  v_or_b32 v10, v10, v11
  v_lshlrev_b32 v10, 6, v10
  v_add_u32 v10, 16384, v10
  v_lshlrev_b32 v11, 6, v6
  v_cmp_gt_u32 vcc, 16, v6
  s_cmp_eq_u32 s37, 1
  s_cselect_b64 s[38:39], vcc, 0
  v_cndmask_b32 v6, v11, v10, s[38:39]
  ds_read_b32 v9, v5 offset:4
  s_waitcnt lgkmcnt(0)
L_x_p1:
  buffer_load_dword v10, v6, s[12:15], s29 offen sc1
  s_waitcnt vmcnt(0)
  v_cmp_ne_u32 vcc, v9, v10
  s_nop 0
  s_cbranch_vccz L_x_p1_o
  s_add_u32 s100, s100, 1
  s_bitcmp1_b32 s100, 21
  s_cbranch_scc0 L_x_p1
L_x_p1_o:
  v_mov_b32 v6, 1
  s_mov_b64 exec, 1
  ds_write_b32 v5, v6 offset:48
  ds_add_u32 v5, v6 offset:36
  s_mov_b64 exec, -1
  s_branch L_l_kv
L_l_b0:
  s_waitcnt vmcnt(0)
  v_mov_b32 v6, 1
  s_mov_b64 exec, 1
  ds_add_u32 v5, v6 offset:36
  s_mov_b64 exec, -1
L_spin_23:
  ds_read_b32 v6, v5 offset:48
  s_waitcnt lgkmcnt(0)
  v_readfirstlane_b32 s35, v6
  s_nop 0
  s_cmp_ge_u32 s35, 1
  s_cbranch_scc1 L_spino_24
  s_add_u32 s100, s100, 1
  s_bitcmp1_b32 s100, 21
  s_cbranch_scc0 L_spin_23
L_spino_24:
L_l_kv:
  s_cmp_eq_u32 s63, 0
  s_cbranch_scc1 L_l_c0
  s_cmp_eq_u32 s37, 1
  s_cbranch_scc1 L_l_ch
  s_add_u32 m0, s33, 0
  s_add_u32 s30, s32, 0
  buffer_load_dwordx4 v4, s[12:15], s30 offen sc1 lds
  s_add_u32 m0, s33, 8256
  s_add_u32 s30, s32, 32768
  buffer_load_dwordx4 v4, s[12:15], s30 offen sc1 lds
  s_add_u32 m0, s33, 16512
  s_add_u32 s30, s32, 65536
  buffer_load_dwordx4 v4, s[12:15], s30 offen sc1 lds
  s_add_u32 m0, s33, 1024
  s_add_u32 s30, s32, 1024
  buffer_load_dwordx4 v4, s[12:15], s30 offen sc1 lds
  s_add_u32 m0, s33, 9280
  s_add_u32 s30, s32, 33792
  buffer_load_dwordx4 v4, s[12:15], s30 offen sc1 lds
  s_add_u32 m0, s33, 17536
  s_add_u32 s30, s32, 66560
  buffer_load_dwordx4 v4, s[12:15], s30 offen sc1 lds
  s_add_u32 m0, s33, 2048
  s_add_u32 s30, s32, 2048
  buffer_load_dwordx4 v4, s[12:15], s30 offen sc1 lds
  s_add_u32 m0, s33, 10304
  s_add_u32 s30, s32, 34816
  buffer_load_dwordx4 v4, s[12:15], s30 offen sc1 lds
  s_add_u32 m0, s33, 18560
  s_add_u32 s30, s32, 67584
  buffer_load_dwordx4 v4, s[12:15], s30 offen sc1 lds
  s_add_u32 m0, s33, 3072
  s_add_u32 s30, s32, 3072
  buffer_load_dwordx4 v4, s[12:15], s30 offen sc1 lds
  s_add_u32 m0, s33, 11328
  s_add_u32 s30, s32, 35840
  buffer_load_dwordx4 v4, s[12:15], s30 offen sc1 lds
  s_add_u32 m0, s33, 19584
  s_add_u32 s30, s32, 68608
  buffer_load_dwordx4 v4, s[12:15], s30 offen sc1 lds
  s_branch L_l_c1
L_l_ch:
  s_add_u32 m0, s33, 0
  s_add_u32 s30, s44, 0
  buffer_load_dwordx4 v4, s[12:15], s30 offen sc1 lds
  s_add_u32 m0, s33, 8256
  s_add_u32 s30, s44, 12288
  buffer_load_dwordx4 v4, s[12:15], s30 offen sc1 lds
  s_add_u32 m0, s33, 16512
  s_add_u32 s30, s44, 24576
  buffer_load_dwordx4 v4, s[12:15], s30 offen sc1 lds
  s_add_u32 m0, s33, 1024
  s_add_u32 s30, s44, 1024
  buffer_load_dwordx4 v4, s[12:15], s30 offen sc1 lds
  s_add_u32 m0, s33, 9280
  s_add_u32 s30, s44, 13312
  buffer_load_dwordx4 v4, s[12:15], s30 offen sc1 lds
  s_add_u32 m0, s33, 17536
  s_add_u32 s30, s44, 25600
  buffer_load_dwordx4 v4, s[12:15], s30 offen sc1 lds
  s_add_u32 m0, s33, 2048
  s_add_u32 s30, s44, 2048
  buffer_load_dwordx4 v4, s[12:15], s30 offen sc1 lds
  s_add_u32 m0, s33, 10304
  s_add_u32 s30, s44, 14336
  buffer_load_dwordx4 v4, s[12:15], s30 offen sc1 lds
  s_add_u32 m0, s33, 18560
  s_add_u32 s30, s44, 26624
  buffer_load_dwordx4 v4, s[12:15], s30 offen sc1 lds
  s_add_u32 m0, s33, 3072
  s_add_u32 s30, s44, 3072
  buffer_load_dwordx4 v4, s[12:15], s30 offen sc1 lds
  s_add_u32 m0, s33, 11328
  s_add_u32 s30, s44, 15360
  buffer_load_dwordx4 v4, s[12:15], s30 offen sc1 lds
  s_add_u32 m0, s33, 19584
  s_add_u32 s30, s44, 27648
  buffer_load_dwordx4 v4, s[12:15], s30 offen sc1 lds
  s_branch L_l_c1
L_l_c0:
  ds_write_b128 v7, v[24:27] offset:0
  ds_write_b128 v7, v[24:27] offset:8256
  ds_write_b128 v7, v[24:27] offset:16512
  ds_write_b128 v7, v[24:27] offset:1024
  ds_write_b128 v7, v[24:27] offset:9280
  ds_write_b128 v7, v[24:27] offset:17536
  ds_write_b128 v7, v[24:27] offset:2048
  ds_write_b128 v7, v[24:27] offset:10304
  ds_write_b128 v7, v[24:27] offset:18560
  ds_write_b128 v7, v[24:27] offset:3072
  ds_write_b128 v7, v[24:27] offset:11328
  ds_write_b128 v7, v[24:27] offset:19584
L_l_c1:
  s_add_u32 m0, s33, 4096
  s_add_u32 s30, s32, 4096
  buffer_load_dwordx4 v4, s[12:15], s30 offen sc1 lds
  s_add_u32 m0, s33, 12352
  s_add_u32 s30, s32, 36864
  buffer_load_dwordx4 v4, s[12:15], s30 offen sc1 lds
  s_add_u32 m0, s33, 20608
  s_add_u32 s30, s32, 69632
  buffer_load_dwordx4 v4, s[12:15], s30 offen sc1 lds
  s_add_u32 m0, s33, 5120
  s_add_u32 s30, s32, 5120
  buffer_load_dwordx4 v4, s[12:15], s30 offen sc1 lds
  s_add_u32 m0, s33, 13376
  s_add_u32 s30, s32, 37888
  buffer_load_dwordx4 v4, s[12:15], s30 offen sc1 lds
  s_add_u32 m0, s33, 21632
  s_add_u32 s30, s32, 70656
  buffer_load_dwordx4 v4, s[12:15], s30 offen sc1 lds
  s_add_u32 m0, s33, 6144
  s_add_u32 s30, s32, 6144
  buffer_load_dwordx4 v4, s[12:15], s30 offen sc1 lds
  s_add_u32 m0, s33, 14400
  s_add_u32 s30, s32, 38912
  buffer_load_dwordx4 v4, s[12:15], s30 offen sc1 lds
  s_add_u32 m0, s33, 22656
  s_add_u32 s30, s32, 71680
  buffer_load_dwordx4 v4, s[12:15], s30 offen sc1 lds
  s_add_u32 m0, s33, 7168
  s_add_u32 s30, s32, 7168
  buffer_load_dwordx4 v4, s[12:15], s30 offen sc1 lds
  s_add_u32 m0, s33, 15424
  s_add_u32 s30, s32, 39936
  buffer_load_dwordx4 v4, s[12:15], s30 offen sc1 lds
  s_add_u32 m0, s33, 23680
  s_add_u32 s30, s32, 72704
  buffer_load_dwordx4 v4, s[12:15], s30 offen sc1 lds
  s_cmp_eq_u32 s21, 0
  s_cbranch_scc1 L_l_noq
  s_lshl_b32 s35, s65, 15
  s_lshl_b32 s34, s63, 12
  s_add_u32 s35, s35, s34
  s_add_u32 s35, s35, 1048576
  s_mov_b32 m0, 107008
  s_add_u32 s30, s35, 0
  buffer_load_dwordx4 v4, s[12:15], s30 offen sc1 lds
  s_mov_b32 m0, 108032
  s_add_u32 s30, s35, 1024
  buffer_load_dwordx4 v4, s[12:15], s30 offen sc1 lds
  s_mov_b32 m0, 109056
  s_add_u32 s30, s35, 2048
  buffer_load_dwordx4 v4, s[12:15], s30 offen sc1 lds
  s_mov_b32 m0, 110080
  s_add_u32 s30, s35, 3072
  buffer_load_dwordx4 v4, s[12:15], s30 offen sc1 lds
  s_mov_b32 m0, 111104
  s_add_u32 s30, s35, 32768
  buffer_load_dwordx4 v4, s[12:15], s30 offen sc1 lds
  s_mov_b32 m0, 112128
  s_add_u32 s30, s35, 33792
  buffer_load_dwordx4 v4, s[12:15], s30 offen sc1 lds
  s_mov_b32 m0, 113152
  s_add_u32 s30, s35, 34816
  buffer_load_dwordx4 v4, s[12:15], s30 offen sc1 lds
  s_mov_b32 m0, 114176
  s_add_u32 s30, s35, 35840
  buffer_load_dwordx4 v4, s[12:15], s30 offen sc1 lds
  s_mov_b32 m0, 115200
  s_add_u32 s30, s35, 65536
  buffer_load_dwordx4 v4, s[12:15], s30 offen sc1 lds
  s_mov_b32 m0, 116224
  s_add_u32 s30, s35, 66560
  buffer_load_dwordx4 v4, s[12:15], s30 offen sc1 lds
  s_mov_b32 m0, 117248
  s_add_u32 s30, s35, 67584
  buffer_load_dwordx4 v4, s[12:15], s30 offen sc1 lds
  s_mov_b32 m0, 118272
  s_add_u32 s30, s35, 68608
  buffer_load_dwordx4 v4, s[12:15], s30 offen sc1 lds
  s_branch L_l_w0
L_l_noq:
L_l_w0:
  s_waitcnt vmcnt(0) lgkmcnt(0)
  s_cmp_eq_u32 s63, 0
  s_cbranch_scc1 L_l_p0
  ds_write_b64 v8, v[20:21] offset:0
  ds_write_b64 v8, v[20:21] offset:1024
  ds_write_b64 v8, v[20:21] offset:2048
  ds_write_b64 v8, v[20:21] offset:3072
  s_branch L_l_p1
L_l_p0:
  ds_write_b64 v8, v[22:23] offset:0
  ds_write_b64 v8, v[22:23] offset:1024
  ds_write_b64 v8, v[22:23] offset:2048
  ds_write_b64 v8, v[22:23] offset:3072
L_l_p1:
  ds_write_b64 v8, v[20:21] offset:4096
  ds_write_b64 v8, v[20:21] offset:5120
  ds_write_b64 v8, v[20:21] offset:6144
  ds_write_b64 v8, v[20:21] offset:7168
  v_mov_b32 v6, 1
  s_waitcnt lgkmcnt(0)
  s_mov_b64 exec, 1
  ds_add_u32 v5, v6 offset:8
  s_mov_b64 exec, -1
  s_and_b32 s67, s18, 7
  s_mul_i32 s69, s67, 160
  v_bfe_u32 v19, v1, 4, 1
  s_lshl_b32 s29, s21, 1
  v_or_b32 v19, s29, v19
  v_lshlrev_b32 v19, 1, v19
  v_and_b32 v152, 7, v1
  v_xor_b32 v152, v152, v19
  v_lshlrev_b32 v152, 4, v152
  v_lshrrev_b32 v19, 3, v1
  v_mul_u32_u24 v19, 1280, v19
  v_add3_u32 v152, v152, v19, s69
  v_bfe_u32 v19, v1, 4, 1
  s_lshl_b32 s29, 1, 1
  v_or_b32 v19, s29, v19
  v_lshlrev_b32 v19, 1, v19
  v_and_b32 v154, 7, v1
  v_xor_b32 v154, v154, v19
  v_lshlrev_b32 v154, 4, v154
  v_lshrrev_b32 v19, 3, v1
  v_mul_u32_u24 v19, 1280, v19
  v_add3_u32 v154, v154, v19, s69
  v_lshrrev_b32 v19, 1, v1
  v_bfe_u32 v153, v19, 3, 1
  v_lshlrev_b32 v153, 2, v153
  v_xor_b32 v19, v19, v153
  v_mul_u32_u24 v19, 1280, v19
  v_and_b32 v153, 1, v1
  v_lshlrev_b32 v153, 4, v153
  v_add3_u32 v153, v153, v19, s69
  v_add_u32 v153, 128, v153
  s_lshl_b32 s34, s21, 10
  s_mul_i32 s35, s21, 10240
  s_add_u32 m0, s34, 49664
  s_add_u32 s30, s35, 0
  buffer_load_dwordx4 v152, s[52:55], s30 offen lds
  s_add_u32 m0, s34, 51712
  s_add_u32 s30, s35, 20480
  buffer_load_dwordx4 v152, s[52:55], s30 offen lds
  s_add_u32 m0, s34, 53760
  s_add_u32 s30, s35, 40960
  buffer_load_dwordx4 v152, s[52:55], s30 offen lds
  s_add_u32 m0, s34, 55808
  s_add_u32 s30, s35, 61440
  buffer_load_dwordx4 v152, s[52:55], s30 offen lds
  s_add_u32 m0, s34, 57856
  s_add_u32 s30, s35, 81920
  buffer_load_dwordx4 v152, s[52:55], s30 offen lds
  s_add_u32 m0, s34, 59904
  s_add_u32 s30, s35, 102400
  buffer_load_dwordx4 v152, s[52:55], s30 offen lds
  s_add_u32 m0, s34, 61952
  s_add_u32 s30, s35, 122880
  buffer_load_dwordx4 v152, s[52:55], s30 offen lds
  s_add_u32 m0, s34, 64000
  s_add_u32 s30, s35, 143360
  buffer_load_dwordx4 v152, s[52:55], s30 offen lds
  s_add_u32 m0, s34, 66048
  s_add_u32 s30, s35, 163840
  buffer_load_dwordx4 v152, s[52:55], s30 offen lds
  s_add_u32 m0, s34, 68096
  s_add_u32 s30, s35, 184320
  buffer_load_dwordx4 v152, s[52:55], s30 offen lds
  s_add_u32 m0, s34, 70144
  s_add_u32 s30, s35, 204800
  buffer_load_dwordx4 v152, s[52:55], s30 offen lds
  s_add_u32 m0, s34, 72192
  s_add_u32 s30, s35, 225280
  buffer_load_dwordx4 v152, s[52:55], s30 offen lds
  s_add_u32 m0, s34, 74240
  s_add_u32 s30, s35, 245760
  buffer_load_dwordx4 v152, s[52:55], s30 offen lds
  s_add_u32 m0, s34, 76288
  s_add_u32 s30, s35, 266240
  buffer_load_dwordx4 v152, s[52:55], s30 offen lds
  s_add_u32 m0, s34, 78336
  s_add_u32 s30, s35, 286720
  buffer_load_dwordx4 v152, s[52:55], s30 offen lds
  s_add_u32 m0, s34, 80384
  s_add_u32 s30, s35, 307200
  buffer_load_dwordx4 v152, s[52:55], s30 offen lds
  s_add_u32 m0, s34, 82432
  s_add_u32 s30, s35, 327680
  buffer_load_dwordx4 v152, s[52:55], s30 offen lds
  s_add_u32 m0, s34, 84480
  s_add_u32 s30, s35, 348160
  buffer_load_dwordx4 v152, s[52:55], s30 offen lds
  s_add_u32 m0, s34, 86528
  s_add_u32 s30, s35, 368640
  buffer_load_dwordx4 v152, s[52:55], s30 offen lds
  s_add_u32 m0, s34, 88576
  s_add_u32 s30, s35, 389120
  buffer_load_dwordx4 v152, s[52:55], s30 offen lds
  s_add_u32 m0, s34, 90624
  s_add_u32 s30, s35, 409600
  buffer_load_dwordx4 v152, s[52:55], s30 offen lds
  s_add_u32 m0, s34, 92672
  s_add_u32 s30, s35, 430080
  buffer_load_dwordx4 v152, s[52:55], s30 offen lds
  s_add_u32 m0, s34, 94720
  s_add_u32 s30, s35, 450560
  buffer_load_dwordx4 v152, s[52:55], s30 offen lds
  s_add_u32 m0, s34, 96768
  s_add_u32 s30, s35, 471040
  buffer_load_dwordx4 v152, s[52:55], s30 offen lds
  s_add_u32 m0, s34, 98816
  s_add_u32 s30, s35, 491520
  buffer_load_dwordx4 v152, s[52:55], s30 offen lds
  s_add_u32 m0, s34, 100864
  s_add_u32 s30, s35, 512000
  buffer_load_dwordx4 v152, s[52:55], s30 offen lds
  s_add_u32 m0, s34, 102912
  s_add_u32 s30, s35, 532480
  buffer_load_dwordx4 v152, s[52:55], s30 offen lds
  s_add_u32 m0, s34, 104960
  s_add_u32 s30, s35, 552960
  buffer_load_dwordx4 v152, s[52:55], s30 offen lds
L_spin_25:
  ds_read_b32 v6, v5 offset:40
  s_waitcnt lgkmcnt(0)
  v_readfirstlane_b32 s35, v6
  s_nop 0
  s_cmp_ge_u32 s35, 8
  s_cbranch_scc1 L_spino_26
  s_add_u32 s100, s100, 1
  s_bitcmp1_b32 s100, 21
  s_cbranch_scc0 L_spin_25
L_spino_26:
  s_mul_i32 s35, s21, 40960
  s_add_u32 m0, s34, 107008
  s_add_u32 s30, s35, 0
  buffer_load_dwordx4 v153, s[52:55], s30 offen lds
  s_add_u32 m0, s34, 109056
  s_add_u32 s30, s35, 81920
  buffer_load_dwordx4 v153, s[52:55], s30 offen lds
  s_add_u32 m0, s34, 111104
  s_add_u32 s30, s35, 163840
  buffer_load_dwordx4 v153, s[52:55], s30 offen lds
  s_add_u32 m0, s34, 113152
  s_add_u32 s30, s35, 245760
  buffer_load_dwordx4 v153, s[52:55], s30 offen lds
  s_add_u32 m0, s34, 115200
  s_add_u32 s30, s35, 327680
  buffer_load_dwordx4 v153, s[52:55], s30 offen lds
  s_add_u32 m0, s34, 117248
  s_add_u32 s30, s35, 409600
  buffer_load_dwordx4 v153, s[52:55], s30 offen lds
  s_add_u32 m0, s34, 119296
  s_add_u32 s30, s35, 491520
  buffer_load_dwordx4 v153, s[52:55], s30 offen lds
  s_add_u32 m0, s34, 121344
  s_add_u32 s30, s35, 573440
  buffer_load_dwordx4 v153, s[52:55], s30 offen lds
  s_add_u32 m0, s34, 123392
  s_add_u32 s30, s35, 655360
  buffer_load_dwordx4 v153, s[52:55], s30 offen lds
  s_add_u32 m0, s34, 125440
  s_add_u32 s30, s35, 737280
  buffer_load_dwordx4 v153, s[52:55], s30 offen lds
  s_cmp_eq_u32 s21, 1
  s_cbranch_scc1 L_l_poll
L_spin_27:
  ds_read_b32 v6, v5 offset:12
  s_waitcnt lgkmcnt(0)
  v_readfirstlane_b32 s35, v6
  s_nop 0
  s_cmp_ge_u32 s35, 8
  s_cbranch_scc1 L_spino_28
  s_add_u32 s100, s100, 1
  s_bitcmp1_b32 s100, 21
  s_cbranch_scc0 L_spin_27
L_spino_28:
  s_mov_b32 m0, 0
  s_mov_b32 s30, 573440
  buffer_load_dwordx4 v152, s[52:55], s30 offen lds
  s_mov_b32 m0, 1024
  s_mov_b32 s30, 583680
  buffer_load_dwordx4 v154, s[52:55], s30 offen lds
  s_mov_b32 m0, 2048
  s_mov_b32 s30, 593920
  buffer_load_dwordx4 v152, s[52:55], s30 offen lds
  s_mov_b32 m0, 3072
  s_mov_b32 s30, 604160
  buffer_load_dwordx4 v154, s[52:55], s30 offen lds
  s_mov_b32 m0, 4096
  s_mov_b32 s30, 614400
  buffer_load_dwordx4 v152, s[52:55], s30 offen lds
  s_mov_b32 m0, 5120
  s_mov_b32 s30, 624640
  buffer_load_dwordx4 v154, s[52:55], s30 offen lds
  s_mov_b32 m0, 6144
  s_mov_b32 s30, 634880
  buffer_load_dwordx4 v152, s[52:55], s30 offen lds
  s_mov_b32 m0, 7168
  s_mov_b32 s30, 645120
  buffer_load_dwordx4 v154, s[52:55], s30 offen lds
  s_mov_b32 m0, 8192
  s_mov_b32 s30, 655360
  buffer_load_dwordx4 v152, s[52:55], s30 offen lds
  s_mov_b32 m0, 9216
  s_mov_b32 s30, 665600
  buffer_load_dwordx4 v154, s[52:55], s30 offen lds
  s_mov_b32 m0, 10240
  s_mov_b32 s30, 675840
  buffer_load_dwordx4 v152, s[52:55], s30 offen lds
  s_mov_b32 m0, 11264
  s_mov_b32 s30, 686080
  buffer_load_dwordx4 v154, s[52:55], s30 offen lds
  s_mov_b32 m0, 12288
  s_mov_b32 s30, 696320
  buffer_load_dwordx4 v152, s[52:55], s30 offen lds
  s_mov_b32 m0, 13312
  s_mov_b32 s30, 706560
  buffer_load_dwordx4 v154, s[52:55], s30 offen lds
  s_mov_b32 m0, 14336
  s_mov_b32 s30, 716800
  buffer_load_dwordx4 v152, s[52:55], s30 offen lds
  s_mov_b32 m0, 15360
  s_mov_b32 s30, 727040
  buffer_load_dwordx4 v154, s[52:55], s30 offen lds
  s_mov_b32 m0, 16384
  s_mov_b32 s30, 737280
  buffer_load_dwordx4 v152, s[52:55], s30 offen lds
  s_mov_b32 m0, 17408
  s_mov_b32 s30, 747520
  buffer_load_dwordx4 v154, s[52:55], s30 offen lds
  s_mov_b32 m0, 18432
  s_mov_b32 s30, 757760
  buffer_load_dwordx4 v152, s[52:55], s30 offen lds
  s_mov_b32 m0, 19456
  s_mov_b32 s30, 768000
  buffer_load_dwordx4 v154, s[52:55], s30 offen lds
  s_mov_b32 m0, 20480
  s_mov_b32 s30, 778240
  buffer_load_dwordx4 v152, s[52:55], s30 offen lds
  s_mov_b32 m0, 21504
  s_mov_b32 s30, 788480
  buffer_load_dwordx4 v154, s[52:55], s30 offen lds
  s_mov_b32 m0, 22528
  s_mov_b32 s30, 798720
  buffer_load_dwordx4 v152, s[52:55], s30 offen lds
  s_mov_b32 m0, 23552
  s_mov_b32 s30, 808960
  buffer_load_dwordx4 v154, s[52:55], s30 offen lds
  s_waitcnt vmcnt(0)
  v_mov_b32 v6, 1
  s_mov_b64 exec, 1
  ds_add_u32 v5, v6 offset:32
  s_mov_b64 exec, -1
  s_endpgm
L_l_poll:
  s_waitcnt vmcnt(0)
  v_mov_b32 v6, 1
  s_mov_b64 exec, 1
  ds_add_u32 v5, v6 offset:32
  s_mov_b64 exec, -1
L_spin_29:
  ds_read_b32 v6, v5 offset:12
  s_waitcnt lgkmcnt(0)
  v_readfirstlane_b32 s35, v6
  s_nop 0
  s_cmp_ge_u32 s35, 8
  s_cbranch_scc1 L_spino_30
  s_add_u32 s100, s100, 1
  s_bitcmp1_b32 s100, 21
  s_cbranch_scc0 L_spin_29
L_spino_30:
  s_lshl_b32 s29, s17, 14
  s_lshr_b32 s30, s18, 3
  s_lshl_b32 s30, s30, 7
  s_add_u32 s29, s29, s30
  s_add_u32 s29, s29, 12320768
  v_lshrrev_b32 v26, 1, v1
  v_lshlrev_b32 v26, 9, v26
  v_and_b32 v27, 1, v1
  v_lshl_add_u32 v26, v27, 6, v26
  ds_read_b32 v6, v5 offset:4
  s_waitcnt lgkmcnt(0)
L_c_poll:
  buffer_load_dword v27, v26, s[12:15], s29 offen sc1
  s_waitcnt vmcnt(0)
  v_cmp_ne_u32 vcc, v6, v27
  s_nop 0
  s_cbranch_vccz L_c_poll_o
  s_add_u32 s100, s100, 1
  s_bitcmp1_b32 s100, 21
  s_cbranch_scc0 L_c_poll
L_c_poll_o:
  v_mov_b32 v6, 1
  s_mov_b64 exec, 1
  ds_write_b32 v5, v6 offset:16
  s_mov_b64 exec, -1
  s_endpgm
L_aux:
  s_load_dwordx2 s[40:41], s[0:1], 72
  v_mov_b32 v2, 0
  v_lshlrev_b32 v6, 2, v1
  v_add_u32 v6, 137472, v6
  s_mov_b32 exec_hi, 0
  ds_write_b32 v6, v2
  s_mov_b64 exec, -1
  s_memrealtime s[54:55]
  s_lshl_b32 s23, s46, 3
  s_add_u32 s23, s23, s20
  s_waitcnt lgkmcnt(0)
  s_mov_b32 s42, 256
  s_mov_b32 s43, 0x20000
  v_mov_b32 v9, 0
  s_cmp_lg_u32 s2, 0
  s_cbranch_scc1 L_x_non
  s_or_b32 s54, s54, 1
  v_mov_b32 v10, s54
  s_mov_b64 exec, 1
  buffer_store_dword v10, v9, s[40:43], 0 offen sc1
  s_mov_b64 exec, -1
L_x_non:
  s_getreg_b32 s52, hwreg(HW_REG_XCC_ID, 0, 4)
  s_and_b32 s52, s52, 7
  s_or_b32 s52, s52, 16
  s_mov_b32 s28, 0xffff0000
  s_barrier
  buffer_load_dword v10, v9, s[40:43], 0 offen sc1
  s_barrier
  s_barrier
  s_waitcnt vmcnt(0)
L_x_wn:
  v_cmp_ne_u32 vcc, 0, v10
  s_nop 0
  s_cbranch_vccnz L_x_gotn
  buffer_load_dword v10, v9, s[40:43], 0 offen sc1
  s_waitcnt vmcnt(0)
  s_add_u32 s100, s100, 1
  s_bitcmp1_b32 s100, 21
  s_cbranch_scc0 L_x_wn
L_x_gotn:
  v_readfirstlane_b32 s61, v10
  v_mov_b32 v6, 137472
  ds_write_b32 v6, v10 offset:4
  s_lshl_b32 s31, s17, 5
  s_add_u32 s31, s31, s18
  s_lshl_b32 s31, s31, 4
  s_add_u32 s31, s31, 328704
  v_mov_b32 v14, s52
  v_mov_b32 v15, v10
  s_mov_b64 exec, 1
  buffer_store_dwordx2 v[14:15], v9, s[12:15], s31 offen sc1
  s_mov_b64 exec, -1
  s_barrier
  v_and_b32 v12, 7, v1
  v_lshlrev_b32 v13, 3, v12
  v_add_u32 v13, 133120, v13
  ds_read_b64 v[18:19], v13
  s_lshl_b32 s29, s23, 3
  s_lshl_b32 s30, s19, 7
  s_add_u32 s29, s29, s30
  s_lshl_b32 s29, s29, 4
  v_lshlrev_b32 v12, 4, v1
  v_mov_b32 v21, s61
  v_mov_b32 v23, s61
  s_waitcnt lgkmcnt(0)
  v_mov_b32 v20, v18
  v_mov_b32 v22, v19
  s_mov_b64 exec, 0xff
  buffer_store_dwordx4 v[20:23], v12, s[12:15], s29 offen sc1
  s_mov_b64 exec, -1
  v_cmp_gt_u32 vcc, 8, v1
  v_mov_b32 v30, 0
  s_nop 0
  v_cndmask_b32 v30, v30, v19, vcc
  v_mov_b32 v32, 0
  s_nop 0
  v_mov_b32_dpp v34, v30 quad_perm:[1,0,3,2] row_mask:0xf bank_mask:0xf
  v_mov_b32_dpp v35, v32 quad_perm:[1,0,3,2] row_mask:0xf bank_mask:0xf
  v_min_u32 v36, v30, v34
  v_max_u32 v30, v30, v34
  v_max3_u32 v32, v32, v35, v36
  s_nop 0
  v_mov_b32_dpp v34, v30 quad_perm:[2,3,0,1] row_mask:0xf bank_mask:0xf
  v_mov_b32_dpp v35, v32 quad_perm:[2,3,0,1] row_mask:0xf bank_mask:0xf
  v_min_u32 v36, v30, v34
  v_max_u32 v30, v30, v34
  v_max3_u32 v32, v32, v35, v36
  s_nop 0
  v_mov_b32_dpp v34, v30 row_half_mirror row_mask:0xf bank_mask:0xf
  v_mov_b32_dpp v35, v32 row_half_mirror row_mask:0xf bank_mask:0xf
  v_min_u32 v36, v30, v34
  v_max_u32 v30, v30, v34
  v_max3_u32 v32, v32, v35, v36
  s_lshl_b32 s29, s2, 4
  s_add_u32 s29, s29, 356352
  v_mov_b32 v28, s29
  v_mov_b32 v31, s61
  v_mov_b32 v33, s61
  s_mov_b64 exec, 1
  buffer_store_dwordx4 v[30:33], v28, s[12:15], 0 offen sc1
  s_mov_b64 exec, -1
  s_barrier
  s_barrier
  s_barrier
  s_barrier
  s_lshl_b32 s29, s19, 11
  s_add_u32 s29, s29, 0
  v_lshlrev_b32 v9, 5, v1
  buffer_load_dwordx4 v[40:43], v9, s[12:15], s29 offen sc1
  buffer_load_dwordx4 v[44:47], v9, s[12:15], s29 offen offset:16 sc1
  s_lshl_b32 s31, s17, 9
  s_add_u32 s31, s31, 328704
  v_and_b32 v16, 31, v1
  v_lshlrev_b32 v16, 4, v16
  buffer_load_dwordx2 v[18:19], v16, s[12:15], s31 offen sc1
  s_barrier
  s_barrier
  s_waitcnt vmcnt(0)
  v_cmp_ne_u32 vcc, s61, v41
  v_cmp_ne_u32 s[62:63], s61, v45
  s_nop 0
  s_or_b64 vcc, vcc, s[62:63]
  s_cbranch_vccz L_x_gdone
L_x_gretry:
  s_lshl_b32 s29, s19, 11
  s_add_u32 s29, s29, 0
  v_lshlrev_b32 v9, 5, v1
  buffer_load_dwordx4 v[40:43], v9, s[12:15], s29 offen sc1
  buffer_load_dwordx4 v[44:47], v9, s[12:15], s29 offen offset:16 sc1
  s_lshl_b32 s31, s17, 9
  s_add_u32 s31, s31, 328704
  v_and_b32 v16, 31, v1
  v_lshlrev_b32 v16, 4, v16
  buffer_load_dwordx2 v[18:19], v16, s[12:15], s31 offen sc1
  s_waitcnt vmcnt(0)
  v_cmp_ne_u32 vcc, s61, v41
  v_cmp_ne_u32 s[62:63], s61, v45
  s_nop 0
  s_or_b64 vcc, vcc, s[62:63]
  s_cbranch_vccz L_x_gdone
  s_add_u32 s100, s100, 1
  s_bitcmp1_b32 s100, 21
  s_cbranch_scc0 L_x_gretry
L_x_gdone:
  v_lshlrev_b32 v24, 16, v40
  v_and_b32 v25, 0xffff0000, v40
  v_lshlrev_b32 v26, 16, v44
  v_and_b32 v27, 0xffff0000, v44
  v_rcp_f32 v25, v25
  v_rcp_f32 v27, v27
  v_lshlrev_b32 v28, 4, v1
  v_add_u32 v28, 131072, v28
  ds_write_b128 v28, v[24:27]
  s_waitcnt vmcnt(0)
  v_cmp_ne_u32 vcc, s52, v18
  v_cmp_ne_u32 s[62:63], s61, v19
  s_nop 0
  s_or_b64 vcc, vcc, s[62:63]
  s_cmp_eq_u64 vcc, 0
  s_cselect_b32 s56, 1, 0
  v_mov_b32 v28, 137472
  v_mov_b32 v29, s56
  ds_write_b32 v28, v29
  s_waitcnt lgkmcnt(0)
  s_barrier
  s_mov_b32 s28, 0xffff0000
  s_setprio 3
  v_lshlrev_b32 v6, 4, v1
  v_add_u32 v6, 356352, v6
L_m_fr:
  buffer_load_dwordx4 v[16:19], v6, s[12:15], 0 offen offset:0 sc1
  buffer_load_dwordx4 v[20:23], v6, s[12:15], 0 offen offset:1024 sc1
  buffer_load_dwordx4 v[24:27], v6, s[12:15], 0 offen offset:2048 sc1
  buffer_load_dwordx4 v[28:31], v6, s[12:15], 0 offen offset:3072 sc1
  s_waitcnt vmcnt(0)
  v_cmp_ne_u32 vcc, s61, v17
  v_cmp_ne_u32 s[62:63], s61, v19
  s_nop 0
  s_or_b64 vcc, vcc, s[62:63]
  v_cmp_ne_u32 s[62:63], s61, v21
  s_nop 0
  s_or_b64 vcc, vcc, s[62:63]
  v_cmp_ne_u32 s[62:63], s61, v23
  s_nop 0
  s_or_b64 vcc, vcc, s[62:63]
  v_cmp_ne_u32 s[62:63], s61, v25
  s_nop 0
  s_or_b64 vcc, vcc, s[62:63]
  v_cmp_ne_u32 s[62:63], s61, v27
  s_nop 0
  s_or_b64 vcc, vcc, s[62:63]
  v_cmp_ne_u32 s[62:63], s61, v29
  s_nop 0
  s_or_b64 vcc, vcc, s[62:63]
  v_cmp_ne_u32 s[62:63], s61, v31
  s_nop 0
  s_or_b64 vcc, vcc, s[62:63]
  s_cbranch_vccz L_ok_31
  s_sleep 12
  s_add_u32 s100, s100, 1
  s_bitcmp1_b32 s100, 21
  s_cbranch_scc0 L_m_fr
L_ok_31:
  v_mov_b32 v8, v16
  v_mov_b32 v10, v18
  v_min_u32 v14, v8, v20
  v_max_u32 v8, v8, v20
  v_max3_u32 v10, v10, v22, v14
  v_min_u32 v14, v8, v24
  v_max_u32 v8, v8, v24
  v_max3_u32 v10, v10, v26, v14
  v_min_u32 v14, v8, v28
  v_max_u32 v8, v8, v28
  v_max3_u32 v10, v10, v30, v14
  s_nop 0
  v_mov_b32_dpp v12, v8 quad_perm:[1,0,3,2] row_mask:0xf bank_mask:0xf
  v_mov_b32_dpp v13, v10 quad_perm:[1,0,3,2] row_mask:0xf bank_mask:0xf
  v_min_u32 v14, v8, v12
  v_max_u32 v8, v8, v12
  v_max3_u32 v10, v10, v13, v14
  s_nop 0
  v_mov_b32_dpp v12, v8 quad_perm:[2,3,0,1] row_mask:0xf bank_mask:0xf
  v_mov_b32_dpp v13, v10 quad_perm:[2,3,0,1] row_mask:0xf bank_mask:0xf
  v_min_u32 v14, v8, v12
  v_max_u32 v8, v8, v12
  v_max3_u32 v10, v10, v13, v14
  s_nop 0
  v_mov_b32_dpp v12, v8 row_half_mirror row_mask:0xf bank_mask:0xf
  v_mov_b32_dpp v13, v10 row_half_mirror row_mask:0xf bank_mask:0xf
  v_min_u32 v14, v8, v12
  v_max_u32 v8, v8, v12
  v_max3_u32 v10, v10, v13, v14
  s_nop 0
  v_mov_b32_dpp v12, v8 row_mirror row_mask:0xf bank_mask:0xf
  v_mov_b32_dpp v13, v10 row_mirror row_mask:0xf bank_mask:0xf
  v_min_u32 v14, v8, v12
  v_max_u32 v8, v8, v12
  v_max3_u32 v10, v10, v13, v14
  v_mov_b32 v12, v8
  v_mov_b32 v13, v10
  s_nop 0
  v_permlane16_swap_b32 v8, v12
  v_permlane16_swap_b32 v10, v13
  v_min_u32 v14, v8, v12
  v_max_u32 v8, v8, v12
  v_max3_u32 v10, v10, v13, v14
  v_mov_b32 v12, v8
  v_mov_b32 v13, v10
  s_nop 0
  v_permlane32_swap_b32 v8, v12
  v_permlane32_swap_b32 v10, v13
  v_min_u32 v14, v8, v12
  v_max_u32 v8, v8, v12
  v_max3_u32 v10, v10, v13, v14
  v_readfirstlane_b32 s64, v8
  v_readfirstlane_b32 s65, v10
  s_and_b32 s66, s64, 0x7ff
  s_sub_u32 s66, 2047, s66
  s_and_b32 s67, s65, 0x7ff
  s_sub_u32 s67, 2047, s67
  v_mov_b32 v6, 137472
  v_mov_b32 v12, s66
  v_mov_b32 v13, s67
  v_mov_b32 v14, 1
  ds_write_b64 v6, v[12:13] offset:24
  s_waitcnt lgkmcnt(0)
  ds_write_b32 v6, v14 offset:20
  s_lshr_b32 s29, s64, 16
  s_and_b32 s30, s29, 0x7fff
  s_xor_b32 s31, s29, 0xffff
  s_bitcmp1_b32 s29, 15
  s_cselect_b32 s68, s30, s31
  s_lshl_b32 s68, s68, 16
  s_lshr_b32 s29, s65, 16
  s_and_b32 s30, s29, 0x7fff
  s_xor_b32 s31, s29, 0xffff
  s_bitcmp1_b32 s29, 15
  s_cselect_b32 s69, s30, s31
  s_lshl_b32 s69, s69, 16
  s_cmp_ge_u32 s2, 240
  s_cbranch_scc1 L_m_s4
  s_mul_i32 s29, s2, 171
  s_lshr_b32 s29, s29, 12
  s_mul_i32 s30, s29, 24
  s_sub_u32 s30, s2, s30
  v_bfe_u32 v6, v1, 4, 1
  v_cmp_eq_u32 vcc, 1, v6
  v_mov_b32 v7, s66
  v_mov_b32 v8, s67
  v_cndmask_b32 v7, v7, v8, vcc
  v_and_b32 v9, 15, v1
  v_mul_u32_u24 v10, 1280, v7
  v_lshl_add_u32 v10, v9, 3, v10
  s_lshl_b32 s31, s29, 7
  v_add_u32 v10, s31, v10
  v_lshlrev_b32 v11, 4, v7
  buffer_load_dwordx2 v[16:17], v10, s[4:7], 0 offen
L_m_st:
  buffer_load_dwordx2 v[14:15], v11, s[12:15], 0 offen sc1
  s_waitcnt vmcnt(0)
  v_cmp_ne_u32 vcc, s61, v15
  s_nop 0
  s_cbranch_vccz L_ok_32
  s_sleep 12
  s_add_u32 s100, s100, 1
  s_bitcmp1_b32 s100, 21
  s_cbranch_scc0 L_m_st
L_ok_32:
  v_lshlrev_b32 v12, 16, v14
  v_and_b32 v13, s28, v14
  v_rcp_f32 v13, v13
  v_lshlrev_b32 v30, 16, v16
  v_and_b32 v31, s28, v16
  v_sub_f32 v30, v30, v12
  v_sub_f32 v31, v31, v12
  v_cvt_pk_bf16_f32 v32, v30, v31
  v_lshlrev_b32 v30, 16, v32
  v_and_b32 v31, s28, v32
  v_mul_f32 v30, v30, v13
  v_mul_f32 v31, v31, v13
  v_cvt_pk_bf16_f32 v16, v30, v31
  v_lshlrev_b32 v30, 16, v17
  v_and_b32 v31, s28, v17
  v_sub_f32 v30, v30, v12
  v_sub_f32 v31, v31, v12
  v_cvt_pk_bf16_f32 v32, v30, v31
  v_lshlrev_b32 v30, 16, v32
  v_and_b32 v31, s28, v32
  v_mul_f32 v30, v30, v13
  v_mul_f32 v31, v31, v13
  v_cvt_pk_bf16_f32 v17, v30, v31
  v_lshlrev_b32 v6, 7, v6
  v_lshl_add_u32 v6, v9, 3, v6
  v_add_u32 v6, 137728, v6
  ds_write_b64 v6, v[16:17]
  v_mov_b32 v6, 137472
  s_waitcnt lgkmcnt(0)
L_spin_33:
  ds_read_b32 v7, v6 offset:36
  s_waitcnt lgkmcnt(0)
  v_readfirstlane_b32 s35, v7
  s_nop 0
  s_cmp_ge_u32 s35, 2
  s_cbranch_scc1 L_spino_34
  s_add_u32 s100, s100, 1
  s_bitcmp1_b32 s100, 21
  s_cbranch_scc0 L_spin_33
L_spino_34:
  v_and_b32 v30, 1, v1
  v_lshlrev_b32 v30, 7, v30
  v_lshrrev_b32 v31, 4, v1
  v_lshl_add_u32 v30, v31, 4, v30
  v_add_u32 v30, 137728, v30
  v_bfe_u32 v32, v1, 2, 2
  v_lshrrev_b32 v33, 1, v32
  v_and_b32 v34, 1, v31
  v_lshl_or_b32 v33, v34, 1, v33
  v_lshl_add_u32 v32, v31, 3, v32
  v_lshlrev_b32 v32, 7, v32
  v_lshl_add_u32 v32, v33, 5, v32
  v_and_b32 v33, 3, v1
  v_lshl_add_u32 v32, v33, 3, v32
  v_add_u32 v32, 138240, v32
  v_xor_b32 v36, 0, v32
  v_xor_b32 v37, 32, v32
  v_xor_b32 v38, 64, v32
  v_xor_b32 v39, 96, v32
  ds_read_b128 v[40:43], v30
  ds_read_b128 v[44:47], v30 offset:64
  ds_read_b64_tr_b16 v[96:97], v36 offset:0
  ds_read_b64_tr_b16 v[98:99], v36 offset:512
  ds_read_b64_tr_b16 v[100:101], v36 offset:4096
  ds_read_b64_tr_b16 v[102:103], v36 offset:4608
  ds_read_b64_tr_b16 v[104:105], v37 offset:0
  ds_read_b64_tr_b16 v[106:107], v37 offset:512
  ds_read_b64_tr_b16 v[108:109], v37 offset:4096
  ds_read_b64_tr_b16 v[110:111], v37 offset:4608
  ds_read_b64_tr_b16 v[112:113], v38 offset:0
  ds_read_b64_tr_b16 v[114:115], v38 offset:512
  ds_read_b64_tr_b16 v[116:117], v38 offset:4096
  ds_read_b64_tr_b16 v[118:119], v38 offset:4608
  ds_read_b64_tr_b16 v[120:121], v39 offset:0
  ds_read_b64_tr_b16 v[122:123], v39 offset:512
  ds_read_b64_tr_b16 v[124:125], v39 offset:4096
  ds_read_b64_tr_b16 v[126:127], v39 offset:4608
  ds_read_b64_tr_b16 v[128:129], v36 offset:8192
  ds_read_b64_tr_b16 v[130:131], v36 offset:8704
  ds_read_b64_tr_b16 v[132:133], v36 offset:12288
  ds_read_b64_tr_b16 v[134:135], v36 offset:12800
  ds_read_b64_tr_b16 v[136:137], v37 offset:8192
  ds_read_b64_tr_b16 v[138:139], v37 offset:8704
  ds_read_b64_tr_b16 v[140:141], v37 offset:12288
  ds_read_b64_tr_b16 v[142:143], v37 offset:12800
  ds_read_b64_tr_b16 v[144:145], v38 offset:8192
  ds_read_b64_tr_b16 v[146:147], v38 offset:8704
  ds_read_b64_tr_b16 v[148:149], v38 offset:12288
  ds_read_b64_tr_b16 v[150:151], v38 offset:12800
  ds_read_b64_tr_b16 v[152:153], v39 offset:8192
  ds_read_b64_tr_b16 v[154:155], v39 offset:8704
  ds_read_b64_tr_b16 v[156:157], v39 offset:12288
  ds_read_b64_tr_b16 v[158:159], v39 offset:12800
  s_waitcnt lgkmcnt(0)
  v_mfma_f32_16x16x32_bf16 v[64:67], v[40:43], v[96:99], 0
  v_mfma_f32_16x16x32_bf16 v[68:71], v[40:43], v[104:107], 0
  v_mfma_f32_16x16x32_bf16 v[72:75], v[40:43], v[112:115], 0
  v_mfma_f32_16x16x32_bf16 v[76:79], v[40:43], v[120:123], 0
  v_mfma_f32_16x16x32_bf16 v[80:83], v[40:43], v[128:131], 0
  v_mfma_f32_16x16x32_bf16 v[84:87], v[40:43], v[136:139], 0
  v_mfma_f32_16x16x32_bf16 v[88:91], v[40:43], v[144:147], 0
  v_mfma_f32_16x16x32_bf16 v[92:95], v[40:43], v[152:155], 0
  v_mfma_f32_16x16x32_bf16 v[64:67], v[44:47], v[100:103], v[64:67]
  v_mfma_f32_16x16x32_bf16 v[68:71], v[44:47], v[108:111], v[68:71]
  v_mfma_f32_16x16x32_bf16 v[72:75], v[44:47], v[116:119], v[72:75]
  v_mfma_f32_16x16x32_bf16 v[76:79], v[44:47], v[124:127], v[76:79]
  v_mfma_f32_16x16x32_bf16 v[80:83], v[44:47], v[132:135], v[80:83]
  v_mfma_f32_16x16x32_bf16 v[84:87], v[44:47], v[140:143], v[84:87]
  v_mfma_f32_16x16x32_bf16 v[88:91], v[44:47], v[148:151], v[88:91]
  v_mfma_f32_16x16x32_bf16 v[92:95], v[44:47], v[156:159], v[92:95]
  s_nop 0
  v_mov_b32 v66, s61
  v_mov_b32 v67, s61
  v_mov_b32 v70, s61
  v_mov_b32 v71, s61
  v_mov_b32 v74, s61
  v_mov_b32 v75, s61
  v_mov_b32 v78, s61
  v_mov_b32 v79, s61
  v_mov_b32 v82, s61
  v_mov_b32 v83, s61
  v_mov_b32 v86, s61
  v_mov_b32 v87, s61
  v_mov_b32 v90, s61
  v_mov_b32 v91, s61
  v_mov_b32 v94, s61
  v_mov_b32 v95, s61
  s_lshl_b32 s29, s2, 11
  s_add_u32 s29, s29, 393216
  v_lshlrev_b32 v6, 4, v1
  s_mov_b64 exec, 0xffff
  buffer_store_dwordx4 v[64:67], v6, s[12:15], s29 offen offset:0 sc1
  buffer_store_dwordx4 v[68:71], v6, s[12:15], s29 offen offset:256 sc1
  buffer_store_dwordx4 v[72:75], v6, s[12:15], s29 offen offset:512 sc1
  buffer_store_dwordx4 v[76:79], v6, s[12:15], s29 offen offset:768 sc1
  buffer_store_dwordx4 v[80:83], v6, s[12:15], s29 offen offset:1024 sc1
  buffer_store_dwordx4 v[84:87], v6, s[12:15], s29 offen offset:1280 sc1
  buffer_store_dwordx4 v[88:91], v6, s[12:15], s29 offen offset:1536 sc1
  buffer_store_dwordx4 v[92:95], v6, s[12:15], s29 offen offset:1792 sc1
  s_mov_b64 exec, -1
  s_mul_i32 s57, s2, 205
  s_lshr_b32 s57, s57, 11
  s_lshl_b32 s29, s57, 11
  s_add_u32 s29, s29, 393216
  v_lshlrev_b32 v6, 4, v1
  v_min_u32 v7, 9, v1
  v_mul_u32_u24 v7, 49152, v7
  v_add_u32 v7, 2040, v7
L_m_p1t:
  buffer_load_dword v8, v7, s[12:15], s29 offen sc1
  s_waitcnt vmcnt(0)
  v_cmp_ne_u32 vcc, s61, v8
  s_nop 0
  s_cbranch_vccz L_ok_35
  s_sleep 12
  s_add_u32 s100, s100, 1
  s_bitcmp1_b32 s100, 21
  s_cbranch_scc0 L_m_p1t
L_ok_35:
L_m_p1:
  s_add_u32 s30, s29, 0
  buffer_load_dwordx4 v[64:67], v6, s[12:15], s30 offen sc1
  buffer_load_dwordx4 v[68:71], v6, s[12:15], s30 offen offset:1024 sc1
  s_add_u32 s30, s29, 49152
  buffer_load_dwordx4 v[72:75], v6, s[12:15], s30 offen sc1
  buffer_load_dwordx4 v[76:79], v6, s[12:15], s30 offen offset:1024 sc1
  s_add_u32 s30, s29, 98304
  buffer_load_dwordx4 v[80:83], v6, s[12:15], s30 offen sc1
  buffer_load_dwordx4 v[84:87], v6, s[12:15], s30 offen offset:1024 sc1
  s_add_u32 s30, s29, 147456
  buffer_load_dwordx4 v[88:91], v6, s[12:15], s30 offen sc1
  buffer_load_dwordx4 v[92:95], v6, s[12:15], s30 offen offset:1024 sc1
  s_add_u32 s30, s29, 196608
  buffer_load_dwordx4 v[96:99], v6, s[12:15], s30 offen sc1
  buffer_load_dwordx4 v[100:103], v6, s[12:15], s30 offen offset:1024 sc1
  s_add_u32 s30, s29, 245760
  buffer_load_dwordx4 v[104:107], v6, s[12:15], s30 offen sc1
  buffer_load_dwordx4 v[108:111], v6, s[12:15], s30 offen offset:1024 sc1
  s_add_u32 s30, s29, 294912
  buffer_load_dwordx4 v[112:115], v6, s[12:15], s30 offen sc1
  buffer_load_dwordx4 v[116:119], v6, s[12:15], s30 offen offset:1024 sc1
  s_add_u32 s30, s29, 344064
  buffer_load_dwordx4 v[120:123], v6, s[12:15], s30 offen sc1
  buffer_load_dwordx4 v[124:127], v6, s[12:15], s30 offen offset:1024 sc1
  s_add_u32 s30, s29, 393216
  buffer_load_dwordx4 v[128:131], v6, s[12:15], s30 offen sc1
  buffer_load_dwordx4 v[132:135], v6, s[12:15], s30 offen offset:1024 sc1
  s_add_u32 s30, s29, 442368
  buffer_load_dwordx4 v[136:139], v6, s[12:15], s30 offen sc1
  buffer_load_dwordx4 v[140:143], v6, s[12:15], s30 offen offset:1024 sc1
  s_waitcnt vmcnt(0)
  v_cmp_ne_u32 vcc, s61, v66
  v_cmp_ne_u32 s[62:63], s61, v70
  s_nop 0
  s_or_b64 vcc, vcc, s[62:63]
  v_cmp_ne_u32 s[62:63], s61, v74
  s_nop 0
  s_or_b64 vcc, vcc, s[62:63]
  v_cmp_ne_u32 s[62:63], s61, v78
  s_nop 0
  s_or_b64 vcc, vcc, s[62:63]
  v_cmp_ne_u32 s[62:63], s61, v82
  s_nop 0
  s_or_b64 vcc, vcc, s[62:63]
  v_cmp_ne_u32 s[62:63], s61, v86
  s_nop 0
  s_or_b64 vcc, vcc, s[62:63]
  v_cmp_ne_u32 s[62:63], s61, v90
  s_nop 0
  s_or_b64 vcc, vcc, s[62:63]
  v_cmp_ne_u32 s[62:63], s61, v94
  s_nop 0
  s_or_b64 vcc, vcc, s[62:63]
  v_cmp_ne_u32 s[62:63], s61, v98
  s_nop 0
  s_or_b64 vcc, vcc, s[62:63]
  v_cmp_ne_u32 s[62:63], s61, v102
  s_nop 0
  s_or_b64 vcc, vcc, s[62:63]
  v_cmp_ne_u32 s[62:63], s61, v106
  s_nop 0
  s_or_b64 vcc, vcc, s[62:63]
  v_cmp_ne_u32 s[62:63], s61, v110
  s_nop 0
  s_or_b64 vcc, vcc, s[62:63]
  v_cmp_ne_u32 s[62:63], s61, v114
  s_nop 0
  s_or_b64 vcc, vcc, s[62:63]
  v_cmp_ne_u32 s[62:63], s61, v118
  s_nop 0
  s_or_b64 vcc, vcc, s[62:63]
  v_cmp_ne_u32 s[62:63], s61, v122
  s_nop 0
  s_or_b64 vcc, vcc, s[62:63]
  v_cmp_ne_u32 s[62:63], s61, v126
  s_nop 0
  s_or_b64 vcc, vcc, s[62:63]
  v_cmp_ne_u32 s[62:63], s61, v130
  s_nop 0
  s_or_b64 vcc, vcc, s[62:63]
  v_cmp_ne_u32 s[62:63], s61, v134
  s_nop 0
  s_or_b64 vcc, vcc, s[62:63]
  v_cmp_ne_u32 s[62:63], s61, v138
  s_nop 0
  s_or_b64 vcc, vcc, s[62:63]
  v_cmp_ne_u32 s[62:63], s61, v142
  s_nop 0
  s_or_b64 vcc, vcc, s[62:63]
  s_cbranch_vccz L_ok_36
  s_sleep 12
  s_add_u32 s100, s100, 1
  s_bitcmp1_b32 s100, 21
  s_cbranch_scc0 L_m_p1
L_ok_36:
  v_mov_b32 v6, 137472
  v_mov_b32 v7, 1
  ds_write_b32 v6, v7 offset:56
  v_add_f32 v64, v64, v72
  v_add_f32 v65, v65, v73
  v_add_f32 v68, v68, v76
  v_add_f32 v69, v69, v77
  v_add_f32 v64, v64, v80
  v_add_f32 v65, v65, v81
  v_add_f32 v68, v68, v84
  v_add_f32 v69, v69, v85
  v_add_f32 v64, v64, v88
  v_add_f32 v65, v65, v89
  v_add_f32 v68, v68, v92
  v_add_f32 v69, v69, v93
  v_add_f32 v64, v64, v96
  v_add_f32 v65, v65, v97
  v_add_f32 v68, v68, v100
  v_add_f32 v69, v69, v101
  v_add_f32 v64, v64, v104
  v_add_f32 v65, v65, v105
  v_add_f32 v68, v68, v108
  v_add_f32 v69, v69, v109
  v_add_f32 v64, v64, v112
  v_add_f32 v65, v65, v113
  v_add_f32 v68, v68, v116
  v_add_f32 v69, v69, v117
  v_add_f32 v64, v64, v120
  v_add_f32 v65, v65, v121
  v_add_f32 v68, v68, v124
  v_add_f32 v69, v69, v125
  v_add_f32 v64, v64, v128
  v_add_f32 v65, v65, v129
  v_add_f32 v68, v68, v132
  v_add_f32 v69, v69, v133
  v_add_f32 v64, v64, v136
  v_add_f32 v65, v65, v137
  v_add_f32 v68, v68, v140
  v_add_f32 v69, v69, v141
  v_cvt_pk_bf16_f32 v64, v64, v64
  v_lshlrev_b32 v64, 16, v64
  v_cvt_pk_bf16_f32 v68, v68, v68
  v_lshlrev_b32 v68, 16, v68
  v_mul_f32 v46, 0xbfb8aa3b, v64
  v_exp_f32 v46, v46
  s_nop 0
  v_add_f32 v46, 1.0, v46
  v_rcp_f32 v46, v46
  s_nop 0
  v_mul_f32 v46, v64, v46
  v_cvt_pk_bf16_f32 v46, v46, v46
  v_lshlrev_b32 v46, 16, v46
  v_mul_f32 v64, v46, v68
  v_cvt_pk_bf16_f32 v65, v65, v65
  v_lshlrev_b32 v65, 16, v65
  v_cvt_pk_bf16_f32 v69, v69, v69
  v_lshlrev_b32 v69, 16, v69
  v_mul_f32 v46, 0xbfb8aa3b, v65
  v_exp_f32 v46, v46
  s_nop 0
  v_add_f32 v46, 1.0, v46
  v_rcp_f32 v46, v46
  s_nop 0
  v_mul_f32 v46, v65, v46
  v_cvt_pk_bf16_f32 v46, v46, v46
  v_lshlrev_b32 v46, 16, v46
  v_mul_f32 v65, v46, v69
  v_cvt_pk_bf16_f32 v16, v64, v65
  v_lshlrev_b32 v6, 1, v1
  v_add_u32 v6, 137984, v6
  ds_write_b16 v6, v16
  ds_write_b16_d16_hi v6, v16 offset:128
  v_mov_b32 v6, 137472
  s_waitcnt lgkmcnt(0)
L_spin_37:
  ds_read_b32 v7, v6 offset:36
  s_waitcnt lgkmcnt(0)
  v_readfirstlane_b32 s35, v7
  s_nop 0
  s_cmp_ge_u32 s35, 2
  s_cbranch_scc1 L_spino_38
  s_add_u32 s100, s100, 1
  s_bitcmp1_b32 s100, 21
  s_cbranch_scc0 L_spin_37
L_spino_38:
  v_and_b32 v30, 1, v1
  v_lshlrev_b32 v30, 7, v30
  v_lshrrev_b32 v31, 4, v1
  v_lshl_add_u32 v30, v31, 4, v30
  v_add_u32 v30, 137984, v30
  v_bfe_u32 v32, v1, 2, 2
  v_lshrrev_b32 v33, 1, v32
  v_and_b32 v34, 1, v31
  v_lshl_or_b32 v33, v34, 1, v33
  v_lshl_add_u32 v32, v31, 3, v32
  v_lshlrev_b32 v32, 7, v32
  v_lshl_add_u32 v32, v33, 5, v32
  v_and_b32 v33, 3, v1
  v_lshl_add_u32 v32, v33, 3, v32
  v_add_u32 v32, 154624, v32
  v_xor_b32 v36, 0, v32
  v_xor_b32 v37, 32, v32
  v_xor_b32 v38, 64, v32
  v_xor_b32 v39, 96, v32
  ds_read_b128 v[40:43], v30
  ds_read_b128 v[44:47], v30 offset:64
  ds_read_b64_tr_b16 v[96:97], v36 offset:0
  ds_read_b64_tr_b16 v[98:99], v36 offset:512
  ds_read_b64_tr_b16 v[100:101], v36 offset:4096
  ds_read_b64_tr_b16 v[102:103], v36 offset:4608
  ds_read_b64_tr_b16 v[104:105], v37 offset:0
  ds_read_b64_tr_b16 v[106:107], v37 offset:512
  ds_read_b64_tr_b16 v[108:109], v37 offset:4096
  ds_read_b64_tr_b16 v[110:111], v37 offset:4608
  ds_read_b64_tr_b16 v[112:113], v38 offset:0
  ds_read_b64_tr_b16 v[114:115], v38 offset:512
  ds_read_b64_tr_b16 v[116:117], v38 offset:4096
  ds_read_b64_tr_b16 v[118:119], v38 offset:4608
  ds_read_b64_tr_b16 v[120:121], v39 offset:0
  ds_read_b64_tr_b16 v[122:123], v39 offset:512
  ds_read_b64_tr_b16 v[124:125], v39 offset:4096
  ds_read_b64_tr_b16 v[126:127], v39 offset:4608
  s_waitcnt lgkmcnt(0)
  v_mfma_f32_16x16x32_bf16 v[64:67], v[40:43], v[96:99], 0
  v_mfma_f32_16x16x32_bf16 v[68:71], v[40:43], v[104:107], 0
  v_mfma_f32_16x16x32_bf16 v[72:75], v[40:43], v[112:115], 0
  v_mfma_f32_16x16x32_bf16 v[76:79], v[40:43], v[120:123], 0
  v_mfma_f32_16x16x32_bf16 v[64:67], v[44:47], v[100:103], v[64:67]
  v_mfma_f32_16x16x32_bf16 v[68:71], v[44:47], v[108:111], v[68:71]
  v_mfma_f32_16x16x32_bf16 v[72:75], v[44:47], v[116:119], v[72:75]
  v_mfma_f32_16x16x32_bf16 v[76:79], v[44:47], v[124:127], v[76:79]
  s_nop 4
  v_mov_b32 v66, s61
  v_mov_b32 v67, s61
  v_mov_b32 v70, s61
  v_mov_b32 v71, s61
  v_mov_b32 v74, s61
  v_mov_b32 v75, s61
  v_mov_b32 v78, s61
  v_mov_b32 v79, s61
  s_lshl_b32 s29, s2, 10
  s_add_u32 s29, s29, 12058624
  v_lshlrev_b32 v6, 4, v1
  s_mov_b64 exec, 0xffff
  buffer_store_dwordx4 v[64:67], v6, s[12:15], s29 offen offset:0 sc1
  buffer_store_dwordx4 v[68:71], v6, s[12:15], s29 offen offset:256 sc1
  buffer_store_dwordx4 v[72:75], v6, s[12:15], s29 offen offset:512 sc1
  buffer_store_dwordx4 v[76:79], v6, s[12:15], s29 offen offset:768 sc1
  s_mov_b64 exec, -1
  s_branch L_m_end
L_m_s4:
  v_mov_b32 v6, 137472
  v_mov_b32 v7, 1
  ds_write_b32 v6, v7 offset:56
  s_cmp_ge_u32 s2, 250
  s_cbranch_scc1 L_m_end
  s_sub_u32 s57, s2, 240
  s_lshl_b32 s29, s57, 10
  s_add_u32 s29, s29, 12058624
  v_lshlrev_b32 v6, 4, v1
  v_min_u32 v7, 23, v1
  v_mul_u32_u24 v7, 10240, v7
  v_add_u32 v7, 1016, v7
L_m_p3t:
  buffer_load_dword v8, v7, s[12:15], s29 offen sc1
  s_waitcnt vmcnt(0)
  v_cmp_ne_u32 vcc, s61, v8
  s_nop 0
  s_cbranch_vccz L_ok_39
  s_sleep 12
  s_add_u32 s100, s100, 1
  s_bitcmp1_b32 s100, 21
  s_cbranch_scc0 L_m_p3t
L_ok_39:
L_m_p3:
  s_add_u32 s30, s29, 0
  buffer_load_dwordx4 v[64:67], v6, s[12:15], s30 offen sc1
  s_add_u32 s30, s29, 10240
  buffer_load_dwordx4 v[68:71], v6, s[12:15], s30 offen sc1
  s_add_u32 s30, s29, 20480
  buffer_load_dwordx4 v[72:75], v6, s[12:15], s30 offen sc1
  s_add_u32 s30, s29, 30720
  buffer_load_dwordx4 v[76:79], v6, s[12:15], s30 offen sc1
  s_add_u32 s30, s29, 40960
  buffer_load_dwordx4 v[80:83], v6, s[12:15], s30 offen sc1
  s_add_u32 s30, s29, 51200
  buffer_load_dwordx4 v[84:87], v6, s[12:15], s30 offen sc1
  s_add_u32 s30, s29, 61440
  buffer_load_dwordx4 v[88:91], v6, s[12:15], s30 offen sc1
  s_add_u32 s30, s29, 71680
  buffer_load_dwordx4 v[92:95], v6, s[12:15], s30 offen sc1
  s_add_u32 s30, s29, 81920
  buffer_load_dwordx4 v[96:99], v6, s[12:15], s30 offen sc1
  s_add_u32 s30, s29, 92160
  buffer_load_dwordx4 v[100:103], v6, s[12:15], s30 offen sc1
  s_add_u32 s30, s29, 102400
  buffer_load_dwordx4 v[104:107], v6, s[12:15], s30 offen sc1
  s_add_u32 s30, s29, 112640
  buffer_load_dwordx4 v[108:111], v6, s[12:15], s30 offen sc1
  s_add_u32 s30, s29, 122880
  buffer_load_dwordx4 v[112:115], v6, s[12:15], s30 offen sc1
  s_add_u32 s30, s29, 133120
  buffer_load_dwordx4 v[116:119], v6, s[12:15], s30 offen sc1
  s_add_u32 s30, s29, 143360
  buffer_load_dwordx4 v[120:123], v6, s[12:15], s30 offen sc1
  s_add_u32 s30, s29, 153600
  buffer_load_dwordx4 v[124:127], v6, s[12:15], s30 offen sc1
  s_add_u32 s30, s29, 163840
  buffer_load_dwordx4 v[128:131], v6, s[12:15], s30 offen sc1
  s_add_u32 s30, s29, 174080
  buffer_load_dwordx4 v[132:135], v6, s[12:15], s30 offen sc1
  s_add_u32 s30, s29, 184320
  buffer_load_dwordx4 v[136:139], v6, s[12:15], s30 offen sc1
  s_add_u32 s30, s29, 194560
  buffer_load_dwordx4 v[140:143], v6, s[12:15], s30 offen sc1
  s_add_u32 s30, s29, 204800
  buffer_load_dwordx4 v[144:147], v6, s[12:15], s30 offen sc1
  s_add_u32 s30, s29, 215040
  buffer_load_dwordx4 v[148:151], v6, s[12:15], s30 offen sc1
  s_add_u32 s30, s29, 225280
  buffer_load_dwordx4 v[152:155], v6, s[12:15], s30 offen sc1
  s_add_u32 s30, s29, 235520
  buffer_load_dwordx4 v[156:159], v6, s[12:15], s30 offen sc1
  s_waitcnt vmcnt(0)
  v_cmp_ne_u32 vcc, s61, v66
  v_cmp_ne_u32 s[62:63], s61, v70
  s_nop 0
  s_or_b64 vcc, vcc, s[62:63]
  v_cmp_ne_u32 s[62:63], s61, v74
  s_nop 0
  s_or_b64 vcc, vcc, s[62:63]
  v_cmp_ne_u32 s[62:63], s61, v78
  s_nop 0
  s_or_b64 vcc, vcc, s[62:63]
  v_cmp_ne_u32 s[62:63], s61, v82
  s_nop 0
  s_or_b64 vcc, vcc, s[62:63]
  v_cmp_ne_u32 s[62:63], s61, v86
  s_nop 0
  s_or_b64 vcc, vcc, s[62:63]
  v_cmp_ne_u32 s[62:63], s61, v90
  s_nop 0
  s_or_b64 vcc, vcc, s[62:63]
  v_cmp_ne_u32 s[62:63], s61, v94
  s_nop 0
  s_or_b64 vcc, vcc, s[62:63]
  v_cmp_ne_u32 s[62:63], s61, v98
  s_nop 0
  s_or_b64 vcc, vcc, s[62:63]
  v_cmp_ne_u32 s[62:63], s61, v102
  s_nop 0
  s_or_b64 vcc, vcc, s[62:63]
  v_cmp_ne_u32 s[62:63], s61, v106
  s_nop 0
  s_or_b64 vcc, vcc, s[62:63]
  v_cmp_ne_u32 s[62:63], s61, v110
  s_nop 0
  s_or_b64 vcc, vcc, s[62:63]
  v_cmp_ne_u32 s[62:63], s61, v114
  s_nop 0
  s_or_b64 vcc, vcc, s[62:63]
  v_cmp_ne_u32 s[62:63], s61, v118
  s_nop 0
  s_or_b64 vcc, vcc, s[62:63]
  v_cmp_ne_u32 s[62:63], s61, v122
  s_nop 0
  s_or_b64 vcc, vcc, s[62:63]
  v_cmp_ne_u32 s[62:63], s61, v126
  s_nop 0
  s_or_b64 vcc, vcc, s[62:63]
  v_cmp_ne_u32 s[62:63], s61, v130
  s_nop 0
  s_or_b64 vcc, vcc, s[62:63]
  v_cmp_ne_u32 s[62:63], s61, v134
  s_nop 0
  s_or_b64 vcc, vcc, s[62:63]
  v_cmp_ne_u32 s[62:63], s61, v138
  s_nop 0
  s_or_b64 vcc, vcc, s[62:63]
  v_cmp_ne_u32 s[62:63], s61, v142
  s_nop 0
  s_or_b64 vcc, vcc, s[62:63]
  v_cmp_ne_u32 s[62:63], s61, v146
  s_nop 0
  s_or_b64 vcc, vcc, s[62:63]
  v_cmp_ne_u32 s[62:63], s61, v150
  s_nop 0
  s_or_b64 vcc, vcc, s[62:63]
  v_cmp_ne_u32 s[62:63], s61, v154
  s_nop 0
  s_or_b64 vcc, vcc, s[62:63]
  v_cmp_ne_u32 s[62:63], s61, v158
  s_nop 0
  s_or_b64 vcc, vcc, s[62:63]
  s_cbranch_vccz L_ok_40
  s_sleep 12
  s_add_u32 s100, s100, 1
  s_bitcmp1_b32 s100, 21
  s_cbranch_scc0 L_m_p3
L_ok_40:
  v_add_f32 v64, v64, v68
  v_add_f32 v65, v65, v69
  v_add_f32 v64, v64, v72
  v_add_f32 v65, v65, v73
  v_add_f32 v64, v64, v76
  v_add_f32 v65, v65, v77
  v_add_f32 v64, v64, v80
  v_add_f32 v65, v65, v81
  v_add_f32 v64, v64, v84
  v_add_f32 v65, v65, v85
  v_add_f32 v64, v64, v88
  v_add_f32 v65, v65, v89
  v_add_f32 v64, v64, v92
  v_add_f32 v65, v65, v93
  v_add_f32 v64, v64, v96
  v_add_f32 v65, v65, v97
  v_add_f32 v64, v64, v100
  v_add_f32 v65, v65, v101
  v_add_f32 v64, v64, v104
  v_add_f32 v65, v65, v105
  v_add_f32 v64, v64, v108
  v_add_f32 v65, v65, v109
  v_add_f32 v64, v64, v112
  v_add_f32 v65, v65, v113
  v_add_f32 v64, v64, v116
  v_add_f32 v65, v65, v117
  v_add_f32 v64, v64, v120
  v_add_f32 v65, v65, v121
  v_add_f32 v64, v64, v124
  v_add_f32 v65, v65, v125
  v_add_f32 v64, v64, v128
  v_add_f32 v65, v65, v129
  v_add_f32 v64, v64, v132
  v_add_f32 v65, v65, v133
  v_add_f32 v64, v64, v136
  v_add_f32 v65, v65, v137
  v_add_f32 v64, v64, v140
  v_add_f32 v65, v65, v141
  v_add_f32 v64, v64, v144
  v_add_f32 v65, v65, v145
  v_add_f32 v64, v64, v148
  v_add_f32 v65, v65, v149
  v_add_f32 v64, v64, v152
  v_add_f32 v65, v65, v153
  v_add_f32 v64, v64, v156
  v_add_f32 v65, v65, v157
  v_cvt_pk_bf16_f32 v64, v64, v64
  v_lshlrev_b32 v64, 16, v64
  v_mov_b32 v46, s68
  v_mul_f32 v46, 0xbfb8aa3b, v46
  v_exp_f32 v46, v46
  s_nop 0
  v_add_f32 v46, 1.0, v46
  v_rcp_f32 v46, v46
  s_nop 0
  v_cvt_pk_bf16_f32 v46, v46, v46
  v_lshlrev_b32 v46, 16, v46
  v_mul_f32 v64, v64, v46
  v_cvt_pk_bf16_f32 v65, v65, v65
  v_lshlrev_b32 v65, 16, v65
  v_mov_b32 v46, s69
  v_mul_f32 v46, 0xbfb8aa3b, v46
  v_exp_f32 v46, v46
  s_nop 0
  v_add_f32 v46, 1.0, v46
  v_rcp_f32 v46, v46
  s_nop 0
  v_cvt_pk_bf16_f32 v46, v46, v46
  v_lshlrev_b32 v46, 16, v46
  v_mul_f32 v65, v65, v46
  v_cvt_pk_bf16_f32 v48, v64, v65
  v_mov_b32 v49, s61
  s_lshl_b32 s29, s57, 9
  s_add_u32 s29, s29, 348160
  v_lshlrev_b32 v6, 3, v1
  buffer_store_dwordx2 v[48:49], v6, s[12:15], s29 offen sc1
L_m_end:
  s_endpgm
.section .rodata,"a"
.p2align 6
.amdhsa_kernel parallel_sum__sliding_block__moe_arch_mod__prompt_kernel
    .amdhsa_next_free_vgpr 168
  .amdhsa_next_free_sgpr 102
  .amdhsa_accum_offset 168
    .amdhsa_group_segment_fixed_size 0
  .amdhsa_kernarg_size 88
  .amdhsa_user_sgpr_count 2
    .amdhsa_user_sgpr_kernarg_segment_ptr 1
  .amdhsa_system_sgpr_workgroup_id_x 1
    .amdhsa_float_denorm_mode_32 3
  .amdhsa_float_denorm_mode_16_64 3
.end_amdhsa_kernel
```
